```python
import torch

def _softmax(x, axis=-1):
    return torch.softmax(x, dim=axis)

def _gelu(x):
    return torch.nn.functional.gelu(x, approximate='tanh')

def _silu(x):
    return torch.nn.functional.silu(x)

def _sigmoid(x):
    return torch.sigmoid(x)

def _layernorm(x, axis=-1, eps=1e-05):
    m = x.mean(dim=axis, keepdim=True)
    v = x.var(dim=axis, keepdim=True, unbiased=False)
    return (x - m) / torch.sqrt(v + eps)

def _scatter_add(tgt, idx, src, axis=0):
    return tgt.clone().index_add_(axis, idx, src)

def _segment_sum(src, seg, n):
    out = torch.zeros((n,) + src.shape[1:], dtype=src.dtype)
    return out.index_add_(0, seg, src)

def _pad(x, pw):
    flat = tuple((v for pair in reversed(pw) for v in pair))
    return torch.nn.functional.pad(x, flat)
kernel_name = 'standalone__autoregressive_conv_wavenet__speech'

def setup_inputs():

    _w = lambda a: (lambda t: t.to(torch.bfloat16) if t.is_floating_point() else t)(torch.as_tensor(a))
    B, T, D, K = (2, 1000, 512, 3)
    return {'x': _w((lambda *s: torch.randn(*s, dtype=torch.bfloat16) * 0.1)(B, T, D)), 'w': _w((lambda *s: torch.randn(*s, dtype=torch.bfloat16) * 0.1)(K, D, 2 * D)), 'w_o': _w((lambda *s: torch.randn(*s, dtype=torch.bfloat16) * 0.05)(D, D))}

def reference(x, w, w_o):
    B, T, D = x.shape
    K = w.shape[0]
    dil = 2
    pad = (K - 1) * dil
    xp = _pad(x, ((0, 0), (pad, 0), (0, 0)))
    h = torch.einsum('btc,cd->btd', xp[:, pad:pad + T, :], w[0])
    for i in range(1, K):
        off = pad - i * dil
        h = h + torch.einsum('btc,cd->btd', xp[:, off:off + T, :], w[i])
    f = h[..., :D].clone()
    g = h[..., D:].clone()
    z = torch.tanh(f) * _sigmoid(g)
    return z @ w_o
```

```asm
; @launch grid=(256,1,1) block=(512,1,1) lds=163840
.amdgcn_target "amdgcn-amd-amdhsa--gfx950"
.text
.globl standalone__autoregressive_conv_wavenet__speech_kernel
.p2align 8
.type standalone__autoregressive_conv_wavenet__speech_kernel,@function
standalone__autoregressive_conv_wavenet__speech_kernel:
    s_cmp_ge_u32 s2, 256
    s_cbranch_scc1 L_end
    s_load_dwordx2 s[24:25], s[0:1], 8
    s_load_dwordx2 s[20:21], s[0:1], 0
    s_load_dwordx4 s[48:51], s[0:1], 16
    s_load_dwordx2 s[54:55], s[0:1], 40
    v_lshrrev_b32 v1, 6, v0
    s_and_b32 s10, s2, 3
    v_readfirstlane_b32 s16, v1
    s_cmp_lg_u32 s16, 5
    s_cbranch_scc1 L_ncp0
    s_getpc_b64 s[36:37]
L_pc0:
    s_bfe_u32 s17, s2, 0x10003
    v_and_b32 v5, 63, v0
    v_lshl_add_u32 v5, v5, 1, s17
    v_lshlrev_b32 v5, 7, v5
    v_cmp_gt_u32 vcc, L_codeend-L_pc0, v5
    s_and_saveexec_b64 s[38:39], vcc
    global_load_dword v118, v5, s[36:37]
    s_mov_b64 exec, -1
L_ncp0:
    s_lshr_b32 s11, s2, 3
    s_bfe_u32 s12, s2, 0x10002
    s_lshr_b32 s15, s2, 7
    s_lshl1_add_u32 s14, s10, s15
    s_cmp_eq_u32 s10, 1
    s_cselect_b32 s6, 1, 0
    s_add_u32 s5, s6, 2
    s_lshr_b32 s5, s11, s5
    s_and_b32 s5, s5, 1
    s_cmp_ge_u32 s16, 4
    s_cbranch_scc1 L_compute
    v_lshrrev_b32 v3, 3, v0
    s_add_u32 s32, s11, s10
    v_lshrrev_b32 v5, 4, v0
    s_and_b32 s32, s32, 3
    v_and_b32 v7, 2, v3
    s_lshl1_add_u32 s32, s32, s12
    v_and_b32 v5, 4, v5
    s_lshr_b32 s17, s11, 2
    s_and_b32 s17, s17, s6
    s_add_u32 s32, s32, s17
    v_and_b32 v4, 7, v0
    v_xor_b32 v7, v7, v5
    s_lshl_b32 s33, s32, 17
    s_lshl_b32 s4, s5, 9
    v_xor_b32 v7, v7, v4
    s_add_u32 s4, s4, s14
    s_lshl_b32 s4, s4, 7
    v_lshlrev_b32 v8, 4, v7
    s_lshl_b32 s31, s16, 11
    v_lshl_add_u32 v15, v3, 11, v8
    s_mov_b32 s26, 3145728
    s_mov_b32 s27, 0x20000
    s_and_b32 s37, s33, 0xe0000
    s_or_b32 s34, s37, s4
    v_and_b32 v2, 63, v0
    s_and_b32 s13, s11, 15
    s_mul_i32 s19, s12, 1024000
    v_and_b32 v3, 7, v3
    s_lshl_b32 s17, s13, 16
    s_lshl_b32 s18, s16, 14
    v_lshlrev_b32 v5, 10, v3
    s_add_u32 s17, s17, s18
    s_sub_u32 s17, s17, 4096
    v_lshl_add_u32 v5, v4, 4, v5
    v_add_u32 v10, s17, v5
    s_mov_b32 s22, 1024000
    s_mov_b32 s23, 0x20000
    v_cmp_gt_u32 vcc, 32, v2
    v_add_u32 v11, 7136, v10
    v_add_u32 v12, 14272, v10
    v_bfrev_b32 v6, 1
    s_lshr_b32 s37, s37, 10
    s_mul_i32 s30, s16, 2112
    v_cndmask_b32 v12, v6, v12, vcc
    s_cmp_lg_u32 s16, 3
    s_cselect_b64 vcc, -1, 0
    s_mov_b32 m0, s31
    s_waitcnt lgkmcnt(0)
    buffer_load_dwordx4 v15, s[24:27], s34 offen lds
    buffer_load_dwordx4 v15, s[24:27], s34 offen offset:1024 lds
    s_add_u32 m0, s31, 8192
    s_xor_b32 s36, s34, 1048576
    buffer_load_dwordx4 v15, s[24:27], s36 offen lds
    buffer_load_dwordx4 v15, s[24:27], s36 offen offset:1024 lds
    s_add_u32 s20, s20, s19
    s_addc_u32 s21, s21, 0
    s_add_u32 m0, s30, 140576
    s_nop 0
    buffer_load_dwordx4 v10, s[20:23], s37 offen offset:0 lds
    buffer_load_dwordx4 v11, s[20:23], s37 offen offset:1056 lds
    s_cbranch_vccnz L_nox1
    buffer_load_dwordx4 v12, s[20:23], s37 offen offset:2112 lds
L_nox1:
    s_add_u32 m0, s31, 16384
    s_xor_b32 s36, s34, 2097152
    buffer_load_dwordx4 v15, s[24:27], s36 offen lds
    buffer_load_dwordx4 v15, s[24:27], s36 offen offset:1024 lds
    s_and_b32 s56, s2, 7
    s_lshr_b32 s59, s11, 3
    s_lshl2_add_u32 s56, s56, s59
    s_and_b32 s57, s11, 7
    s_mul_i32 s59, s59, 2
    s_lshl_b32 s58, s59, 16
    v_and_b32 v5, 4, v3
    v_add_u32 v5, v5, v3
    v_lshl_add_u32 v8, v5, 10, v8
    s_and_b32 s17, s16, 1
    s_lshl_b32 s17, s17, 12
    s_and_b32 s18, s16, 2
    s_lshl_b32 s18, s18, 13
    s_add_u32 s17, s17, s18
    s_lshl_b32 s18, s57, 7
    s_add_u32 s17, s17, s18
    v_add_u32 v20, s17, v8
    s_mov_b32 s40, s48
    s_mov_b32 s41, s49
    s_mov_b32 s42, 524288
    s_mov_b32 s43, 0x20000
    s_lshl_b32 s17, s56, 7
    s_lshl_b32 s28, s57, 12
    s_add_u32 s17, s17, s28
    s_add_u32 s7, s17, 8388608
    v_lshl_add_u32 v26, v2, 13, s7
    v_mov_b32 v29, 0
    v_lshlrev_b32 v9, 4, v2
    s_mov_b32 s60, s54
    s_mov_b32 s61, s55
    s_mov_b32 s62, 4194304
    s_mov_b32 s63, 0x20000
    s_mov_b32 s67, 0x7fa57fa5
    s_lshl4_add_u32 s17, s12, s13
    s_lshl_b32 s17, s17, 16
    s_lshl_b32 s28, s14, 11
    s_add_u32 s17, s17, s28
    s_lshl_b32 s28, s16, 14
    s_add_u32 s17, s17, s28
    s_and_b32 s28, s16, 2
    s_lshl_b32 s28, s28, 12
    s_xor_b32 s17, s17, s28
    s_or_b32 s17, s17, 2097152
    v_add_u32 v18, s17, v9
    s_mov_b32 s47, s17
    v_mov_b32 v32, s67
    v_mov_b32 v33, s67
    v_mov_b32 v34, s67
    v_mov_b32 v35, s67
    s_lshl_b32 s3, s16, 10
    s_lshl_b32 s44, s56, 16
    s_or_b32 s44, s44, 2097152
    s_lshl_b32 s29, s59, 11
    s_lshr_b32 s45, s16, 1
    s_mul_i32 s45, s45, 40960
    s_and_b32 s46, s3, 1024
    s_or_b32 s45, s45, s46
    s_or_b32 s45, s45, s44
    s_or_b32 s46, s45, 16384
    s_or_b32 s28, s29, s44
    s_mov_b64 s[52:53], 0
    s_mov_b32 s39, 0
    s_load_dword s9, s[54:55], s47 offset:1792
    s_load_dword s9, s[54:55], s47 offset:1920
    s_cbranch_vccnz L_w32
    s_mov_b64 exec, 1
    global_store_dword v26, v29, s[54:55] sc1
    s_mov_b64 exec, -1
L_w32:
    s_add_u32 m0, s31, 24576
    s_xor_b32 s36, s34, 65536
    buffer_load_dwordx4 v15, s[24:27], s36 offen lds
    buffer_load_dwordx4 v15, s[24:27], s36 offen offset:1024 lds
    s_add_u32 m0, s31, 32768
    s_xor_b32 s36, s34, 1114112
    buffer_load_dwordx4 v15, s[24:27], s36 offen lds
    buffer_load_dwordx4 v15, s[24:27], s36 offen offset:1024 lds
    s_add_u32 m0, s31, 40960
    s_xor_b32 s36, s34, 2162688
    buffer_load_dwordx4 v15, s[24:27], s36 offen lds
    buffer_load_dwordx4 v15, s[24:27], s36 offen offset:1024 lds
    s_add_u32 s33, s33, 0x20000
    s_and_b32 s37, s33, 0xe0000
    s_or_b32 s34, s37, s4
    s_lshr_b32 s37, s37, 10
    s_add_u32 m0, s30, 150080
    s_nop 0
    buffer_load_dwordx4 v10, s[20:23], s37 offen offset:0 lds
    buffer_load_dwordx4 v11, s[20:23], s37 offen offset:1056 lds
    s_cbranch_vccnz L_nox3
    buffer_load_dwordx4 v12, s[20:23], s37 offen offset:2112 lds
L_nox3:
    s_add_u32 m0, s31, 49152
    s_nop 0
    buffer_load_dwordx4 v15, s[24:27], s34 offen lds
    buffer_load_dwordx4 v15, s[24:27], s34 offen offset:1024 lds
    s_add_u32 m0, s31, 57344
    s_xor_b32 s36, s34, 1048576
    s_waitcnt vmcnt(12)
    s_cbranch_vccz L_wt4
    s_waitcnt vmcnt(10)
L_wt4:
    s_barrier
    buffer_load_dwordx4 v15, s[24:27], s36 offen lds
    buffer_load_dwordx4 v15, s[24:27], s36 offen offset:1024 lds
    s_add_u32 m0, s31, 65536
    s_xor_b32 s36, s34, 2097152
    buffer_load_dwordx4 v15, s[24:27], s36 offen lds
    buffer_load_dwordx4 v15, s[24:27], s36 offen offset:1024 lds
    s_add_u32 m0, s31, 73728
    s_xor_b32 s36, s34, 65536
    buffer_load_dwordx4 v15, s[24:27], s36 offen lds
    buffer_load_dwordx4 v15, s[24:27], s36 offen offset:1024 lds
    s_add_u32 m0, s31, 81920
    s_xor_b32 s36, s34, 1114112
    s_waitcnt vmcnt(11)
    s_cbranch_vccz L_wt5
    s_waitcnt vmcnt(10)
L_wt5:
    s_barrier
    buffer_load_dwordx4 v15, s[24:27], s36 offen lds
    buffer_load_dwordx4 v15, s[24:27], s36 offen offset:1024 lds
    s_add_u32 m0, s31, 90112
    s_xor_b32 s36, s34, 2162688
    buffer_load_dwordx4 v15, s[24:27], s36 offen lds
    buffer_load_dwordx4 v15, s[24:27], s36 offen offset:1024 lds
    s_add_u32 s33, s33, 0x20000
    s_and_b32 s37, s33, 0xe0000
    s_or_b32 s34, s37, s4
    s_lshr_b32 s37, s37, 10
    s_add_u32 m0, s30, 131072
    s_nop 0
    buffer_load_dwordx4 v10, s[20:23], s37 offen offset:0 lds
    buffer_load_dwordx4 v11, s[20:23], s37 offen offset:1056 lds
    s_cbranch_vccnz L_nox6
    buffer_load_dwordx4 v12, s[20:23], s37 offen offset:2112 lds
L_nox6:
    s_add_u32 m0, s31, 98304
    s_nop 0
    buffer_load_dwordx4 v15, s[24:27], s34 offen lds
    buffer_load_dwordx4 v15, s[24:27], s34 offen offset:1024 lds
    s_add_u32 m0, s31, 106496
    s_xor_b32 s36, s34, 1048576
    s_waitcnt vmcnt(11)
    s_cbranch_vccz L_wt7
    s_waitcnt vmcnt(10)
L_wt7:
    s_barrier
    buffer_load_dwordx4 v15, s[24:27], s36 offen lds
    buffer_load_dwordx4 v15, s[24:27], s36 offen offset:1024 lds
    s_add_u32 m0, s31, 114688
    s_xor_b32 s36, s34, 2097152
    buffer_load_dwordx4 v15, s[24:27], s36 offen lds
    buffer_load_dwordx4 v15, s[24:27], s36 offen offset:1024 lds
    s_add_u32 m0, s31, 122880
    s_xor_b32 s36, s34, 65536
    buffer_load_dwordx4 v15, s[24:27], s36 offen lds
    buffer_load_dwordx4 v15, s[24:27], s36 offen offset:1024 lds
    s_mov_b32 m0, s31
    s_xor_b32 s36, s34, 1114112
    s_waitcnt vmcnt(11)
    s_cbranch_vccz L_wt8
    s_waitcnt vmcnt(10)
L_wt8:
    s_barrier
    buffer_load_dwordx4 v15, s[24:27], s36 offen lds
    buffer_load_dwordx4 v15, s[24:27], s36 offen offset:1024 lds
    s_add_u32 m0, s31, 8192
    s_xor_b32 s36, s34, 2162688
    buffer_load_dwordx4 v15, s[24:27], s36 offen lds
    buffer_load_dwordx4 v15, s[24:27], s36 offen offset:1024 lds
    s_add_u32 s33, s33, 0x20000
    s_and_b32 s37, s33, 0xe0000
    s_or_b32 s34, s37, s4
    s_lshr_b32 s37, s37, 10
    s_add_u32 m0, s30, 140576
    s_nop 0
    buffer_load_dwordx4 v10, s[20:23], s37 offen offset:0 lds
    buffer_load_dwordx4 v11, s[20:23], s37 offen offset:1056 lds
    s_cbranch_vccnz L_nox9
    buffer_load_dwordx4 v12, s[20:23], s37 offen offset:2112 lds
L_nox9:
    s_add_u32 m0, s31, 16384
    s_nop 0
    buffer_load_dwordx4 v15, s[24:27], s34 offen lds
    buffer_load_dwordx4 v15, s[24:27], s34 offen offset:1024 lds
    s_add_u32 m0, s31, 24576
    s_xor_b32 s36, s34, 1048576
    s_waitcnt vmcnt(11)
    s_cbranch_vccz L_wt10
    s_waitcnt vmcnt(10)
L_wt10:
    s_barrier
    buffer_load_dwordx4 v15, s[24:27], s36 offen lds
    buffer_load_dwordx4 v15, s[24:27], s36 offen offset:1024 lds
    s_add_u32 m0, s31, 32768
    s_xor_b32 s36, s34, 2097152
    buffer_load_dwordx4 v15, s[24:27], s36 offen lds
    buffer_load_dwordx4 v15, s[24:27], s36 offen offset:1024 lds
    s_add_u32 m0, s31, 40960
    s_xor_b32 s36, s34, 65536
    buffer_load_dwordx4 v15, s[24:27], s36 offen lds
    buffer_load_dwordx4 v15, s[24:27], s36 offen offset:1024 lds
    s_add_u32 m0, s31, 49152
    s_xor_b32 s36, s34, 1114112
    s_waitcnt vmcnt(11)
    s_cbranch_vccz L_wt11
    s_waitcnt vmcnt(10)
L_wt11:
    s_barrier
    buffer_load_dwordx4 v15, s[24:27], s36 offen lds
    buffer_load_dwordx4 v15, s[24:27], s36 offen offset:1024 lds
    s_add_u32 m0, s31, 57344
    s_xor_b32 s36, s34, 2162688
    buffer_load_dwordx4 v15, s[24:27], s36 offen lds
    buffer_load_dwordx4 v15, s[24:27], s36 offen offset:1024 lds
    s_add_u32 s33, s33, 0x20000
    s_and_b32 s37, s33, 0xe0000
    s_or_b32 s34, s37, s4
    s_lshr_b32 s37, s37, 10
    s_add_u32 m0, s30, 150080
    s_nop 0
    buffer_load_dwordx4 v10, s[20:23], s37 offen offset:0 lds
    buffer_load_dwordx4 v11, s[20:23], s37 offen offset:1056 lds
    s_cbranch_vccnz L_nox12
    buffer_load_dwordx4 v12, s[20:23], s37 offen offset:2112 lds
L_nox12:
    s_add_u32 m0, s31, 65536
    s_nop 0
    buffer_load_dwordx4 v15, s[24:27], s34 offen lds
    buffer_load_dwordx4 v15, s[24:27], s34 offen offset:1024 lds
    s_add_u32 m0, s31, 73728
    s_xor_b32 s36, s34, 1048576
    s_waitcnt vmcnt(11)
    s_cbranch_vccz L_wt13
    s_waitcnt vmcnt(10)
L_wt13:
    s_barrier
    buffer_load_dwordx4 v15, s[24:27], s36 offen lds
    buffer_load_dwordx4 v15, s[24:27], s36 offen offset:1024 lds
    s_add_u32 m0, s31, 81920
    s_xor_b32 s36, s34, 2097152
    buffer_load_dwordx4 v15, s[24:27], s36 offen lds
    buffer_load_dwordx4 v15, s[24:27], s36 offen offset:1024 lds
    s_add_u32 m0, s31, 90112
    s_xor_b32 s36, s34, 65536
    buffer_load_dwordx4 v15, s[24:27], s36 offen lds
    buffer_load_dwordx4 v15, s[24:27], s36 offen offset:1024 lds
    s_add_u32 m0, s31, 98304
    s_xor_b32 s36, s34, 1114112
    s_waitcnt vmcnt(11)
    s_cbranch_vccz L_wt14
    s_waitcnt vmcnt(10)
L_wt14:
    s_barrier
    buffer_load_dwordx4 v15, s[24:27], s36 offen lds
    buffer_load_dwordx4 v15, s[24:27], s36 offen offset:1024 lds
    s_add_u32 m0, s31, 106496
    s_xor_b32 s36, s34, 2162688
    buffer_load_dwordx4 v15, s[24:27], s36 offen lds
    buffer_load_dwordx4 v15, s[24:27], s36 offen offset:1024 lds
    s_add_u32 s33, s33, 0x20000
    s_and_b32 s37, s33, 0xe0000
    s_or_b32 s34, s37, s4
    s_lshr_b32 s37, s37, 10
    s_add_u32 m0, s30, 131072
    s_nop 0
    buffer_load_dwordx4 v10, s[20:23], s37 offen offset:0 lds
    buffer_load_dwordx4 v11, s[20:23], s37 offen offset:1056 lds
    s_cbranch_vccnz L_nox15
    buffer_load_dwordx4 v12, s[20:23], s37 offen offset:2112 lds
L_nox15:
    s_add_u32 m0, s31, 114688
    s_nop 0
    buffer_load_dwordx4 v15, s[24:27], s34 offen lds
    buffer_load_dwordx4 v15, s[24:27], s34 offen offset:1024 lds
    s_add_u32 m0, s31, 122880
    s_xor_b32 s36, s34, 1048576
    s_waitcnt vmcnt(11)
    s_cbranch_vccz L_wt16
    s_waitcnt vmcnt(10)
L_wt16:
    s_barrier
    buffer_load_dwordx4 v15, s[24:27], s36 offen lds
    buffer_load_dwordx4 v15, s[24:27], s36 offen offset:1024 lds
    s_mov_b32 m0, s31
    s_xor_b32 s36, s34, 2097152
    buffer_load_dwordx4 v15, s[24:27], s36 offen lds
    buffer_load_dwordx4 v15, s[24:27], s36 offen offset:1024 lds
    s_add_u32 m0, s31, 8192
    s_xor_b32 s36, s34, 65536
    buffer_load_dwordx4 v15, s[24:27], s36 offen lds
    buffer_load_dwordx4 v15, s[24:27], s36 offen offset:1024 lds
    s_add_u32 m0, s31, 16384
    s_xor_b32 s36, s34, 1114112
    s_waitcnt vmcnt(11)
    s_cbranch_vccz L_wt17
    s_waitcnt vmcnt(10)
L_wt17:
    s_barrier
    buffer_load_dwordx4 v15, s[24:27], s36 offen lds
    buffer_load_dwordx4 v15, s[24:27], s36 offen offset:1024 lds
    s_add_u32 m0, s31, 24576
    s_xor_b32 s36, s34, 2162688
    buffer_load_dwordx4 v15, s[24:27], s36 offen lds
    buffer_load_dwordx4 v15, s[24:27], s36 offen offset:1024 lds
    s_add_u32 s33, s33, 0x20000
    s_and_b32 s37, s33, 0xe0000
    s_or_b32 s34, s37, s4
    s_lshr_b32 s37, s37, 10
    s_add_u32 m0, s30, 140576
    s_nop 0
    buffer_load_dwordx4 v10, s[20:23], s37 offen offset:0 lds
    buffer_load_dwordx4 v11, s[20:23], s37 offen offset:1056 lds
    s_cbranch_vccnz L_nox18
    buffer_load_dwordx4 v12, s[20:23], s37 offen offset:2112 lds
L_nox18:
    s_add_u32 m0, s31, 32768
    s_nop 0
    buffer_load_dwordx4 v15, s[24:27], s34 offen lds
    buffer_load_dwordx4 v15, s[24:27], s34 offen offset:1024 lds
    s_add_u32 m0, s31, 40960
    s_xor_b32 s36, s34, 1048576
    s_waitcnt vmcnt(11)
    s_cbranch_vccz L_wt19
    s_waitcnt vmcnt(10)
L_wt19:
    s_barrier
    buffer_load_dwordx4 v15, s[24:27], s36 offen lds
    buffer_load_dwordx4 v15, s[24:27], s36 offen offset:1024 lds
    s_add_u32 m0, s31, 49152
    s_xor_b32 s36, s34, 2097152
    buffer_load_dwordx4 v15, s[24:27], s36 offen lds
    buffer_load_dwordx4 v15, s[24:27], s36 offen offset:1024 lds
    s_add_u32 m0, s31, 57344
    s_xor_b32 s36, s34, 65536
    buffer_load_dwordx4 v15, s[24:27], s36 offen lds
    buffer_load_dwordx4 v15, s[24:27], s36 offen offset:1024 lds
    s_add_u32 m0, s31, 65536
    s_xor_b32 s36, s34, 1114112
    s_waitcnt vmcnt(11)
    s_cbranch_vccz L_wt20
    s_waitcnt vmcnt(10)
L_wt20:
    s_barrier
    buffer_load_dwordx4 v15, s[24:27], s36 offen lds
    buffer_load_dwordx4 v15, s[24:27], s36 offen offset:1024 lds
    s_add_u32 m0, s31, 73728
    s_xor_b32 s36, s34, 2162688
    buffer_load_dwordx4 v15, s[24:27], s36 offen lds
    buffer_load_dwordx4 v15, s[24:27], s36 offen offset:1024 lds
    s_add_u32 s33, s33, 0x20000
    s_and_b32 s37, s33, 0xe0000
    s_or_b32 s34, s37, s4
    s_lshr_b32 s37, s37, 10
    s_add_u32 m0, s30, 150080
    s_nop 0
    buffer_load_dwordx4 v10, s[20:23], s37 offen offset:0 lds
    buffer_load_dwordx4 v11, s[20:23], s37 offen offset:1056 lds
    s_cbranch_vccnz L_nox21
    buffer_load_dwordx4 v12, s[20:23], s37 offen offset:2112 lds
L_nox21:
    s_add_u32 m0, s31, 81920
    s_nop 0
    buffer_load_dwordx4 v15, s[24:27], s34 offen lds
    buffer_load_dwordx4 v15, s[24:27], s34 offen offset:1024 lds
    s_add_u32 m0, s31, 90112
    s_xor_b32 s36, s34, 1048576
    s_waitcnt vmcnt(11)
    s_cbranch_vccz L_wt22
    s_waitcnt vmcnt(10)
L_wt22:
    s_barrier
    buffer_load_dwordx4 v15, s[24:27], s36 offen lds
    buffer_load_dwordx4 v15, s[24:27], s36 offen offset:1024 lds
    s_add_u32 m0, s31, 98304
    s_xor_b32 s36, s34, 2097152
    buffer_load_dwordx4 v15, s[24:27], s36 offen lds
    buffer_load_dwordx4 v15, s[24:27], s36 offen offset:1024 lds
    s_add_u32 m0, s31, 106496
    s_xor_b32 s36, s34, 65536
    buffer_load_dwordx4 v15, s[24:27], s36 offen lds
    buffer_load_dwordx4 v15, s[24:27], s36 offen offset:1024 lds
    s_add_u32 m0, s31, 114688
    s_xor_b32 s36, s34, 1114112
    s_waitcnt vmcnt(11)
    s_cbranch_vccz L_wt23
    s_waitcnt vmcnt(10)
L_wt23:
    s_barrier
    buffer_load_dwordx4 v15, s[24:27], s36 offen lds
    buffer_load_dwordx4 v15, s[24:27], s36 offen offset:1024 lds
    s_add_u32 m0, s31, 122880
    s_xor_b32 s36, s34, 2162688
    buffer_load_dwordx4 v15, s[24:27], s36 offen lds
    buffer_load_dwordx4 v15, s[24:27], s36 offen offset:1024 lds
    s_add_u32 m0, s3, 159744
    s_and_b32 s17, s58, 0x7ffff
    buffer_load_dwordx4 v20, s[40:43], s17 offen lds
    s_add_u32 s58, s58, 32768
    s_add_u32 m0, s3, 0
    s_and_b32 s17, s58, 0x7ffff
    buffer_load_dwordx4 v20, s[40:43], s17 offen lds
    s_add_u32 s58, s58, 32768
    s_waitcnt vmcnt(8)
    s_barrier
    s_add_u32 m0, s3, 4096
    s_and_b32 s17, s58, 0x7ffff
    buffer_load_dwordx4 v20, s[40:43], s17 offen lds
    s_add_u32 s58, s58, 32768
    s_add_u32 m0, s3, 8192
    s_and_b32 s17, s58, 0x7ffff
    buffer_load_dwordx4 v20, s[40:43], s17 offen lds
    s_add_u32 s58, s58, 32768
    s_add_u32 m0, s3, 12288
    s_and_b32 s17, s58, 0x7ffff
    buffer_load_dwordx4 v20, s[40:43], s17 offen lds
    s_add_u32 s58, s58, 32768
    s_add_u32 m0, s3, 16384
    s_and_b32 s17, s58, 0x7ffff
    buffer_load_dwordx4 v20, s[40:43], s17 offen lds
    s_add_u32 s58, s58, 32768
    buffer_store_dwordx4 v[32:35], v18, s[60:63], 0 offen offset:0 sc1
    buffer_store_dwordx4 v[32:35], v18, s[60:63], 0 offen offset:1024 sc1
    s_waitcnt vmcnt(12)
    s_barrier
    s_add_u32 m0, s3, 20480
    s_and_b32 s17, s58, 0x7ffff
    buffer_load_dwordx4 v20, s[40:43], s17 offen lds
    s_add_u32 s58, s58, 32768
    s_add_u32 m0, s3, 24576
    s_and_b32 s17, s58, 0x7ffff
    buffer_load_dwordx4 v20, s[40:43], s17 offen lds
    s_add_u32 s58, s58, 32768
    s_waitcnt vmcnt(12)
    s_barrier
    s_add_u32 m0, s3, 28672
    s_and_b32 s17, s58, 0x7ffff
    buffer_load_dwordx4 v20, s[40:43], s17 offen lds
    s_add_u32 s58, s58, 32768
    s_add_u32 m0, s3, 131072
    s_and_b32 s17, s58, 0x7ffff
    buffer_load_dwordx4 v20, s[40:43], s17 offen lds
    s_add_u32 s58, s58, 32768
    s_waitcnt vmcnt(12)
    s_barrier
    s_add_u32 m0, s3, 135168
    s_and_b32 s17, s58, 0x7ffff
    buffer_load_dwordx4 v20, s[40:43], s17 offen lds
    s_add_u32 s58, s58, 32768
    s_add_u32 m0, s3, 32768
    s_and_b32 s17, s58, 0x7ffff
    buffer_load_dwordx4 v20, s[40:43], s17 offen lds
    s_add_u32 s58, s58, 32768
    s_add_u32 m0, s3, 36864
    s_and_b32 s17, s58, 0x7ffff
    buffer_load_dwordx4 v20, s[40:43], s17 offen lds
    s_add_u32 s58, s58, 32768
    s_add_u32 m0, s3, 40960
    s_and_b32 s17, s58, 0x7ffff
    buffer_load_dwordx4 v20, s[40:43], s17 offen lds
    s_add_u32 s58, s58, 32768
    s_add_u32 m0, s3, 45056
    s_and_b32 s17, s58, 0x7ffff
    buffer_load_dwordx4 v20, s[40:43], s17 offen lds
    s_add_u32 s58, s58, 32768
    s_add_u32 m0, s3, 49152
    s_and_b32 s17, s58, 0x7ffff
    buffer_load_dwordx4 v20, s[40:43], s17 offen lds
    s_add_u32 s58, s58, 32768
    s_waitcnt vmcnt(10)
    s_barrier
    s_mov_b32 m0, 65536
    s_cbranch_vccnz L_nop
L_hp1:
    s_load_dword s52, s[54:55], s7 glc
    s_add_u32 s39, s39, 1
    s_cmp_eq_u32 s52, 8
    s_cbranch_scc1 L_hok
    s_cmp_eq_u32 s52, 8
    s_cbranch_scc1 L_hok
    s_cmp_eq_u32 s52, 8
    s_cbranch_scc1 L_hok
    s_cmp_eq_u32 s52, 8
    s_cbranch_scc1 L_hok
    s_cmp_eq_u32 s52, 8
    s_cbranch_scc1 L_hok
    s_cmp_eq_u32 s52, 8
    s_cbranch_scc1 L_hok
    s_cmp_eq_u32 s52, 8
    s_cbranch_scc1 L_hok
    s_cmp_eq_u32 s52, 8
    s_cbranch_scc1 L_hok
    s_cmp_eq_u32 s52, 8
    s_cbranch_scc1 L_hok
    s_cmp_eq_u32 s52, 8
    s_cbranch_scc1 L_hok
    s_cmp_eq_u32 s52, 8
    s_cbranch_scc1 L_hok
    s_cmp_eq_u32 s52, 8
    s_cbranch_scc1 L_hok
    s_cmp_eq_u32 s52, 8
    s_cbranch_scc1 L_hok
    s_cmp_eq_u32 s52, 8
    s_cbranch_scc1 L_hok
    s_cmp_eq_u32 s52, 8
    s_cbranch_scc1 L_hok
    s_cmp_eq_u32 s52, 8
    s_cbranch_scc1 L_hok
    s_cmp_lt_u32 s39, 524288
    s_cbranch_scc1 L_hp1
L_hok:
    buffer_load_dwordx4 v9, s[60:63], s28 offen offset:0 sc1 lds
    buffer_load_dwordx4 v9, s[60:63], s28 offen offset:1024 sc1 lds
    s_mov_b32 m0, 67584
    s_xor_b32 s28, s28, 40960
    buffer_load_dwordx4 v9, s[60:63], s28 offen offset:0 sc1 lds
    buffer_load_dwordx4 v9, s[60:63], s28 offen offset:1024 sc1 lds
    s_waitcnt vmcnt(4)
    s_branch L_h
L_nop:
    s_waitcnt vmcnt(0)
L_h:
    s_add_u32 s28, s29, 2048
    s_and_b32 s28, s28, 0x3800
    s_add_u32 m0, s3, 69632
    s_xor_b32 s28, s28, s45
    s_barrier
    buffer_load_dwordx4 v9, s[60:63], s28 offen sc1 lds
    s_add_u32 s28, s29, 4096
    s_and_b32 s28, s28, 0x3800
    s_add_u32 m0, s3, 73728
    s_xor_b32 s28, s28, s45
    buffer_load_dwordx4 v9, s[60:63], s28 offen sc1 lds
    s_add_u32 s28, s29, 6144
    s_and_b32 s28, s28, 0x3800
    s_add_u32 m0, s3, 77824
    s_xor_b32 s28, s28, s45
    buffer_load_dwordx4 v9, s[60:63], s28 offen sc1 lds
    s_add_u32 s28, s29, 8192
    s_and_b32 s28, s28, 0x3800
    s_add_u32 m0, s3, 81920
    s_xor_b32 s28, s28, s45
    buffer_load_dwordx4 v9, s[60:63], s28 offen sc1 lds
    s_add_u32 s28, s29, 10240
    s_and_b32 s28, s28, 0x3800
    s_add_u32 m0, s3, 86016
    s_xor_b32 s28, s28, s45
    buffer_load_dwordx4 v9, s[60:63], s28 offen sc1 lds
    s_add_u32 s28, s29, 12288
    s_and_b32 s28, s28, 0x3800
    s_add_u32 m0, s3, 90112
    s_xor_b32 s28, s28, s45
    buffer_load_dwordx4 v9, s[60:63], s28 offen sc1 lds
    s_add_u32 s28, s29, 14336
    s_and_b32 s28, s28, 0x3800
    s_add_u32 m0, s3, 94208
    s_xor_b32 s28, s28, s45
    buffer_load_dwordx4 v9, s[60:63], s28 offen sc1 lds
    s_add_u32 s28, s29, 0
    s_and_b32 s28, s28, 0x3800
    s_add_u32 m0, s3, 98304
    s_xor_b32 s28, s28, s46
    buffer_load_dwordx4 v9, s[60:63], s28 offen sc1 lds
    s_add_u32 s28, s29, 2048
    s_and_b32 s28, s28, 0x3800
    s_add_u32 m0, s3, 102400
    s_xor_b32 s28, s28, s46
    buffer_load_dwordx4 v9, s[60:63], s28 offen sc1 lds
    s_waitcnt vmcnt(8)
    s_barrier
    s_add_u32 s28, s29, 4096
    s_and_b32 s28, s28, 0x3800
    s_add_u32 m0, s3, 106496
    s_xor_b32 s28, s28, s46
    buffer_load_dwordx4 v9, s[60:63], s28 offen sc1 lds
    s_add_u32 s28, s29, 6144
    s_and_b32 s28, s28, 0x3800
    s_add_u32 m0, s3, 110592
    s_xor_b32 s28, s28, s46
    buffer_load_dwordx4 v9, s[60:63], s28 offen sc1 lds
    s_waitcnt vmcnt(8)
    s_barrier
    s_add_u32 s28, s29, 8192
    s_and_b32 s28, s28, 0x3800
    s_add_u32 m0, s3, 114688
    s_xor_b32 s28, s28, s46
    buffer_load_dwordx4 v9, s[60:63], s28 offen sc1 lds
    s_add_u32 s28, s29, 10240
    s_and_b32 s28, s28, 0x3800
    s_add_u32 m0, s3, 118784
    s_xor_b32 s28, s28, s46
    buffer_load_dwordx4 v9, s[60:63], s28 offen sc1 lds
    s_waitcnt vmcnt(8)
    s_barrier
    s_add_u32 s28, s29, 12288
    s_and_b32 s28, s28, 0x3800
    s_add_u32 m0, s3, 122880
    s_xor_b32 s28, s28, s46
    buffer_load_dwordx4 v9, s[60:63], s28 offen sc1 lds
    s_add_u32 s28, s29, 14336
    s_and_b32 s28, s28, 0x3800
    s_add_u32 m0, s3, 126976
    s_xor_b32 s28, s28, s46
    buffer_load_dwordx4 v9, s[60:63], s28 offen sc1 lds
    s_waitcnt vmcnt(8)
    s_barrier
    s_waitcnt vmcnt(6)
    s_barrier
    s_waitcnt vmcnt(4)
    s_barrier
    s_waitcnt vmcnt(2)
    s_barrier
    s_waitcnt vmcnt(0)
    s_barrier
    s_endpgm
L_compute:
    s_sub_u32 s16, s16, 4
    v_and_b32 v2, 63, v0
    s_and_b32 s13, s11, 15
    s_mov_b32 s34, 9504
    s_mov_b32 s35, -19008
    s_lshl4_add_u32 s18, s12, s13
    s_lshl_b32 s17, s18, 16
    s_lshl_b32 s33, s14, 11
    s_add_u32 s17, s17, s33
    s_lshl_b32 s33, s16, 9
    s_add_u32 s17, s17, s33
    s_or_b32 s17, s17, 2097152
    v_lshlrev_b32 v9, 4, v2
    v_lshrrev_b32 v3, 5, v2
    v_mul_u32_u24 v3, 40960, v3
    v_and_b32 v8, 0x1f0, v9
    v_or_b32 v3, v3, v8
    v_xor_b32 v10, s17, v3
    v_add_u32 v11, 16384, v10
    s_lshl_b32 s17, s18, 7
    s_add_u32 s17, s17, 8388608
    v_and_b32 v114, 15, v2
    v_lshlrev_b32 v114, 12, v114
    v_add_u32 v114, s17, v114
    v_mov_b32 v115, 1
    s_cmp_eq_u32 s16, 0
    s_cselect_b32 s94, 255, 0
    s_mov_b32 s95, 0
    v_and_b32 v3, 1, v2
    v_bfe_u32 v8, v2, 1, 3
    v_lshrrev_b32 v26, 4, v2
    v_mul_u32_u24 v28, 1056, v8
    v_lshl_add_u32 v28, v3, 7, v28
    v_lshl_add_u32 v28, v26, 4, v28
    s_lshl_b32 s17, s5, 6
    s_add_u32 s18, s17, 140576
    s_sub_u32 s17, 140640, s17
    v_add_u32 v18, s18, v28
    v_add_u32 v19, s17, v28
    s_and_b32 s56, s2, 7
    s_lshr_b32 s59, s11, 3
    s_lshl2_add_u32 s56, s56, s59
    s_and_b32 s57, s11, 7
    s_mul_i32 s59, s59, 2
    s_and_b32 s17, s56, 15
    s_lshl_b32 s17, s17, 16
    s_lshr_b32 s58, s16, 1
    s_lshl_b32 s18, s58, 11
    s_add_u32 s17, s17, s18
    s_lshl_b32 s18, s57, 7
    s_add_u32 s17, s17, s18
    s_and_b32 s33, s16, 1
    s_lshl_b32 s18, s33, 6
    s_add_u32 s17, s17, s18
    v_lshlrev_b32 v24, 10, v3
    v_lshl_add_u32 v24, v8, 13, v24
    v_and_b32 v28, 1, v26
    v_lshl_add_u32 v24, v28, 5, v24
    v_lshrrev_b32 v28, 1, v26
    v_lshl_add_u32 v24, v28, 4, v24
    v_add_u32 v24, s17, v24
    v_add_u32 v25, 4096, v24
    v_bfe_u32 v3, v2, 2, 2
    v_and_b32 v8, 3, v2
    v_lshrrev_b32 v28, 1, v3
    v_and_b32 v29, 1, v26
    v_lshl_add_u32 v28, v29, 1, v28
    s_lshl_b32 s33, s33, 1
    v_xor_b32 v14, s33, v28
    v_xor_b32 v28, s16, v28
    v_lshlrev_b32 v29, 11, v26
    v_lshl_add_u32 v29, v3, 7, v29
    v_lshl_add_u32 v29, v8, 3, v29
    v_lshl_add_u32 v56, v28, 5, v29
    v_add_u32 v57, 8192, v56
    v_add_u32 v58, 16384, v56
    v_add_u32 v59, 24576, v56
    v_add_u32 v60, 32768, v56
    v_add_u32 v61, 40960, v56
    v_lshlrev_b32 v29, 10, v26
    v_lshl_add_u32 v29, v3, 7, v29
    v_lshl_add_u32 v29, v8, 3, v29
    v_lshl_add_u32 v14, v14, 5, v29
    v_xor_b32 v15, 32, v14
    v_add_u32 v116, 131072, v14
    v_add_u32 v117, 131072, v15
    s_lshl_b32 s17, s58, 11
    s_add_u32 s17, s17, 65536
    v_add_u32 v23, s17, v9
    v_mov_b32 v32, 0
    v_mov_b32 v33, 0
    v_mov_b32 v34, 0
    v_mov_b32 v35, 0
    v_mov_b32 v36, 0
    v_mov_b32 v37, 0
    v_mov_b32 v38, 0
    v_mov_b32 v39, 0
    v_mov_b32 v40, 0
    v_mov_b32 v41, 0
    v_mov_b32 v42, 0
    v_mov_b32 v43, 0
    v_mov_b32 v44, 0
    v_mov_b32 v45, 0
    v_mov_b32 v46, 0
    v_mov_b32 v47, 0
    v_mov_b32 v48, 0
    v_mov_b32 v49, 0
    v_mov_b32 v50, 0
    v_mov_b32 v51, 0
    v_mov_b32 v52, 0
    v_mov_b32 v53, 0
    v_mov_b32 v54, 0
    v_mov_b32 v55, 0
    v_mov_b32 v120, 0
    v_mov_b32 v121, 0
    v_mov_b32 v122, 0
    v_mov_b32 v123, 0
    v_mov_b32 v124, 0
    v_mov_b32 v125, 0
    v_mov_b32 v126, 0
    v_mov_b32 v127, 0
    s_lshr_b32 s17, s56, 4
    s_mul_i32 s17, s17, 1024000
    s_mov_b32 s42, 0x4038aa3b
    s_mov_b32 s43, 0x4038aa3b
    s_mov_b32 s30, 0xbfb8aa3b
    s_mov_b32 s31, 0xbfb8aa3b
    s_mov_b32 s28, 0x3f800002
    s_mov_b32 s29, 0x3f800002
    s_mov_b32 s40, 49152
    s_mov_b32 s41, 0x1ffff
    s_mov_b32 s39, 0
    s_waitcnt lgkmcnt(0)
    s_cmp_lg_u32 s16, 2
    s_cbranch_scc1 L_npw
    s_cmp_eq_u32 s14, 3
    s_cbranch_scc1 L_npw
    v_and_b32 v4, 16, v2
    v_cmp_eq_u32 vcc, 0, v4
    v_and_b32 v4, 15, v2
    v_lshrrev_b32 v7, 5, v2
    v_lshlrev_b32 v7, 18, v7
    s_lshl_b32 s18, s11, 14
    s_add_u32 s18, s18, 384
    v_lshl_add_u32 v5, v4, 10, s18
    s_lshl_b32 s18, s2, 11
    v_lshl_add_u32 v6, v4, 7, s18
    v_cndmask_b32 v5, v6, v5, vcc
    v_add_u32 v5, v5, v7
    s_cmp_eq_u32 s14, 2
    s_cselect_b32 exec_hi, -1, 0
    global_load_dword v119, v5, s[48:49]
    s_mov_b32 exec_hi, -1
L_npw:
    s_add_u32 s4, s50, s17
    s_addc_u32 s5, s51, 0
    s_mov_b32 s6, 1024000
    s_mov_b32 s7, 0x20000
    s_mov_b32 s60, s54
    s_mov_b32 s61, s55
    s_mov_b32 s62, 4194304
    s_mov_b32 s63, 0x20000
    s_mov_b32 s67, 0x7fa57fa5
    s_barrier
    ds_read_b64_tr_b16 v[88:89], v56 offset:0
    ds_read_b64_tr_b16 v[90:91], v56 offset:512
    ds_read_b128 v[72:75], v18 offset:512
    ds_read_b128 v[76:79], v18 offset:768
    ds_read_b128 v[80:83], v18 offset:1056
    ds_read_b128 v[84:87], v18 offset:1312
    ds_read_b64_tr_b16 v[92:93], v56 offset:1024
    ds_read_b64_tr_b16 v[94:95], v56 offset:1536
    ds_read_b64_tr_b16 v[96:97], v57 offset:0
    ds_read_b64_tr_b16 v[98:99], v57 offset:512
    ds_read_b128 v[68:71], v18 offset:256
    ds_read_b64_tr_b16 v[100:101], v57 offset:1024
    ds_read_b64_tr_b16 v[102:103], v57 offset:1536
    ds_read_b64_tr_b16 v[104:105], v58 offset:0
    ds_read_b64_tr_b16 v[106:107], v58 offset:512
    ds_read_b128 v[64:67], v18 offset:0
    ds_read_b64_tr_b16 v[108:109], v58 offset:1024
    ds_read_b64_tr_b16 v[110:111], v58 offset:1536
.p2align 6
L_cmain:
    s_waitcnt lgkmcnt(10)
    v_mfma_f32_16x16x32_bf16 v[32:35], v[88:91], v[72:75], v[32:35]
    v_mfma_f32_16x16x32_bf16 v[36:39], v[92:95], v[72:75], v[36:39]
    v_add_u32 v56, s40, v56
    v_mfma_f32_16x16x32_bf16 v[44:47], v[92:95], v[76:79], v[44:47]
    v_add_u32 v57, s40, v57
    v_mfma_f32_16x16x32_bf16 v[40:43], v[88:91], v[76:79], v[40:43]
    v_mfma_f32_16x16x32_bf16 v[48:51], v[88:91], v[80:83], v[48:51]
    v_add_u32 v58, s40, v58
    v_mfma_f32_16x16x32_bf16 v[52:55], v[92:95], v[80:83], v[52:55]
    v_and_b32 v56, s41, v56
    v_mfma_f32_16x16x32_bf16 v[124:127], v[92:95], v[84:87], v[124:127]
    v_and_b32 v57, s41, v57
    v_mfma_f32_16x16x32_bf16 v[120:123], v[88:91], v[84:87], v[120:123]
    s_waitcnt lgkmcnt(5)
    v_mfma_f32_16x16x32_bf16 v[32:35], v[96:99], v[68:71], v[32:35]
    v_and_b32 v58, s41, v58
    v_mfma_f32_16x16x32_bf16 v[36:39], v[100:103], v[68:71], v[36:39]
    v_add_u32 v18, s34, v18
    v_mfma_f32_16x16x32_bf16 v[44:47], v[100:103], v[72:75], v[44:47]
    s_add_u32 s39, s39, 1
    v_mfma_f32_16x16x32_bf16 v[40:43], v[96:99], v[72:75], v[40:43]
    s_barrier
    v_mfma_f32_16x16x32_bf16 v[48:51], v[96:99], v[76:79], v[48:51]
    ds_read_b64_tr_b16 v[152:153], v59 offset:0
    v_mfma_f32_16x16x32_bf16 v[52:55], v[100:103], v[76:79], v[52:55]
    ds_read_b64_tr_b16 v[154:155], v59 offset:512
    ds_read_b128 v[136:139], v19 offset:512
    v_mfma_f32_16x16x32_bf16 v[124:127], v[100:103], v[80:83], v[124:127]
    ds_read_b128 v[140:143], v19 offset:768
    v_mfma_f32_16x16x32_bf16 v[120:123], v[96:99], v[80:83], v[120:123]
    ds_read_b128 v[144:147], v19 offset:1056
    ds_read_b128 v[148:151], v19 offset:1312
    s_waitcnt lgkmcnt(6)
    v_mfma_f32_16x16x32_bf16 v[32:35], v[104:107], v[64:67], v[32:35]
    ds_read_b64_tr_b16 v[156:157], v59 offset:1024
    v_mfma_f32_16x16x32_bf16 v[36:39], v[108:111], v[64:67], v[36:39]
    ds_read_b64_tr_b16 v[158:159], v59 offset:1536
    ds_read_b64_tr_b16 v[160:161], v60 offset:0
    v_mfma_f32_16x16x32_bf16 v[44:47], v[108:111], v[68:71], v[44:47]
    ds_read_b64_tr_b16 v[162:163], v60 offset:512
    v_mfma_f32_16x16x32_bf16 v[40:43], v[104:107], v[68:71], v[40:43]
    ds_read_b128 v[132:135], v19 offset:256
    ds_read_b64_tr_b16 v[164:165], v60 offset:1024
    v_mfma_f32_16x16x32_bf16 v[48:51], v[104:107], v[72:75], v[48:51]
    ds_read_b64_tr_b16 v[166:167], v60 offset:1536
    v_mfma_f32_16x16x32_bf16 v[52:55], v[108:111], v[72:75], v[52:55]
    ds_read_b64_tr_b16 v[168:169], v61 offset:0
    ds_read_b64_tr_b16 v[170:171], v61 offset:512
    v_mfma_f32_16x16x32_bf16 v[124:127], v[108:111], v[76:79], v[124:127]
    ds_read_b128 v[128:131], v19 offset:0
    v_mfma_f32_16x16x32_bf16 v[120:123], v[104:107], v[76:79], v[120:123]
    ds_read_b64_tr_b16 v[172:173], v61 offset:1024
    ds_read_b64_tr_b16 v[174:175], v61 offset:1536
    s_waitcnt lgkmcnt(10)
    v_mfma_f32_16x16x32_bf16 v[32:35], v[152:155], v[136:139], v[32:35]
    v_add_u32 v19, s34, v19
    v_mfma_f32_16x16x32_bf16 v[36:39], v[156:159], v[136:139], v[36:39]
    v_add_u32 v59, s40, v59
    v_mfma_f32_16x16x32_bf16 v[44:47], v[156:159], v[140:143], v[44:47]
    v_add_u32 v60, s40, v60
    v_mfma_f32_16x16x32_bf16 v[40:43], v[152:155], v[140:143], v[40:43]
    v_add_u32 v61, s40, v61
    v_mfma_f32_16x16x32_bf16 v[48:51], v[152:155], v[144:147], v[48:51]
    v_and_b32 v59, s41, v59
    v_mfma_f32_16x16x32_bf16 v[52:55], v[156:159], v[144:147], v[52:55]
    v_and_b32 v60, s41, v60
    v_mfma_f32_16x16x32_bf16 v[124:127], v[156:159], v[148:151], v[124:127]
    v_and_b32 v61, s41, v61
    v_mfma_f32_16x16x32_bf16 v[120:123], v[152:155], v[148:151], v[120:123]
    s_add_u32 s36, s34, s35
    s_waitcnt lgkmcnt(5)
    v_mfma_f32_16x16x32_bf16 v[32:35], v[160:163], v[132:135], v[32:35]
    s_mov_b32 s34, s35
    v_mfma_f32_16x16x32_bf16 v[36:39], v[164:167], v[132:135], v[36:39]
    s_sub_u32 s35, 0, s36
    v_mfma_f32_16x16x32_bf16 v[44:47], v[164:167], v[136:139], v[44:47]
    s_cmp_lt_u32 s39, 7
    v_mfma_f32_16x16x32_bf16 v[40:43], v[160:163], v[136:139], v[40:43]
    s_barrier
    v_mfma_f32_16x16x32_bf16 v[48:51], v[160:163], v[140:143], v[48:51]
    ds_read_b64_tr_b16 v[88:89], v56 offset:0
    v_mfma_f32_16x16x32_bf16 v[52:55], v[164:167], v[140:143], v[52:55]
    ds_read_b64_tr_b16 v[90:91], v56 offset:512
    ds_read_b128 v[72:75], v18 offset:512
    v_mfma_f32_16x16x32_bf16 v[124:127], v[164:167], v[144:147], v[124:127]
    ds_read_b128 v[76:79], v18 offset:768
    v_mfma_f32_16x16x32_bf16 v[120:123], v[160:163], v[144:147], v[120:123]
    ds_read_b128 v[80:83], v18 offset:1056
    ds_read_b128 v[84:87], v18 offset:1312
    s_waitcnt lgkmcnt(6)
    v_mfma_f32_16x16x32_bf16 v[32:35], v[168:171], v[128:131], v[32:35]
    ds_read_b64_tr_b16 v[92:93], v56 offset:1024
    v_mfma_f32_16x16x32_bf16 v[36:39], v[172:175], v[128:131], v[36:39]
    ds_read_b64_tr_b16 v[94:95], v56 offset:1536
    ds_read_b64_tr_b16 v[96:97], v57 offset:0
    v_mfma_f32_16x16x32_bf16 v[44:47], v[172:175], v[132:135], v[44:47]
    ds_read_b64_tr_b16 v[98:99], v57 offset:512
    v_mfma_f32_16x16x32_bf16 v[40:43], v[168:171], v[132:135], v[40:43]
    ds_read_b128 v[68:71], v18 offset:256
    ds_read_b64_tr_b16 v[100:101], v57 offset:1024
    v_mfma_f32_16x16x32_bf16 v[48:51], v[168:171], v[136:139], v[48:51]
    ds_read_b64_tr_b16 v[102:103], v57 offset:1536
    v_mfma_f32_16x16x32_bf16 v[52:55], v[172:175], v[136:139], v[52:55]
    ds_read_b64_tr_b16 v[104:105], v58 offset:0
    ds_read_b64_tr_b16 v[106:107], v58 offset:512
    v_mfma_f32_16x16x32_bf16 v[124:127], v[172:175], v[140:143], v[124:127]
    ds_read_b128 v[64:67], v18 offset:0
    v_mfma_f32_16x16x32_bf16 v[120:123], v[168:171], v[140:143], v[120:123]
    ds_read_b64_tr_b16 v[108:109], v58 offset:1024
    ds_read_b64_tr_b16 v[110:111], v58 offset:1536
    s_cbranch_scc1 L_cmain
    s_waitcnt lgkmcnt(10)
    v_mfma_f32_16x16x32_bf16 v[32:35], v[88:91], v[72:75], v[32:35]
    ds_read_b128 v[136:139], v19 offset:512
    v_mfma_f32_16x16x32_bf16 v[36:39], v[92:95], v[72:75], v[36:39]
    ds_read_b128 v[140:143], v19 offset:768
    v_mfma_f32_16x16x32_bf16 v[44:47], v[92:95], v[76:79], v[44:47]
    ds_read_b128 v[144:147], v19 offset:1056
    v_mfma_f32_16x16x32_bf16 v[40:43], v[88:91], v[76:79], v[40:43]
    ds_read_b128 v[148:151], v19 offset:1312
    v_mfma_f32_16x16x32_bf16 v[48:51], v[88:91], v[80:83], v[48:51]
    ds_read_b128 v[132:135], v19 offset:256
    v_mfma_f32_16x16x32_bf16 v[52:55], v[92:95], v[80:83], v[52:55]
    ds_read_b128 v[128:131], v19 offset:0
    v_mfma_f32_16x16x32_bf16 v[124:127], v[92:95], v[84:87], v[124:127]
    v_mfma_f32_16x16x32_bf16 v[120:123], v[88:91], v[84:87], v[120:123]
    s_waitcnt lgkmcnt(11)
    v_mfma_f32_16x16x32_bf16 v[32:35], v[96:99], v[68:71], v[32:35]
    v_mfma_f32_16x16x32_bf16 v[36:39], v[100:103], v[68:71], v[36:39]
    v_mfma_f32_16x16x32_bf16 v[44:47], v[100:103], v[72:75], v[44:47]
    v_mfma_f32_16x16x32_bf16 v[40:43], v[96:99], v[72:75], v[40:43]
    s_barrier
    ds_read_b64_tr_b16 v[152:153], v59 offset:0
    ds_read_b64_tr_b16 v[154:155], v59 offset:512
    v_mfma_f32_16x16x32_bf16 v[48:51], v[96:99], v[76:79], v[48:51]
    ds_read_b64_tr_b16 v[156:157], v59 offset:1024
    ds_read_b64_tr_b16 v[158:159], v59 offset:1536
    v_mfma_f32_16x16x32_bf16 v[52:55], v[100:103], v[76:79], v[52:55]
    v_mfma_f32_16x16x32_bf16 v[124:127], v[100:103], v[80:83], v[124:127]
    v_mfma_f32_16x16x32_bf16 v[120:123], v[96:99], v[80:83], v[120:123]
    s_waitcnt lgkmcnt(10)
    v_mfma_f32_16x16x32_bf16 v[32:35], v[104:107], v[64:67], v[32:35]
    v_mfma_f32_16x16x32_bf16 v[36:39], v[108:111], v[64:67], v[36:39]
    v_mfma_f32_16x16x32_bf16 v[44:47], v[108:111], v[68:71], v[44:47]
    v_mfma_f32_16x16x32_bf16 v[40:43], v[104:107], v[68:71], v[40:43]
    v_mfma_f32_16x16x32_bf16 v[48:51], v[104:107], v[72:75], v[48:51]
    v_mfma_f32_16x16x32_bf16 v[52:55], v[108:111], v[72:75], v[52:55]
    v_mfma_f32_16x16x32_bf16 v[124:127], v[108:111], v[76:79], v[124:127]
    v_mfma_f32_16x16x32_bf16 v[120:123], v[104:107], v[76:79], v[120:123]
    s_barrier
    ds_read_b64_tr_b16 v[160:161], v60 offset:0
    ds_read_b64_tr_b16 v[162:163], v60 offset:512
    s_waitcnt lgkmcnt(2)
    v_mfma_f32_16x16x32_bf16 v[32:35], v[152:155], v[136:139], v[32:35]
    ds_read_b64_tr_b16 v[164:165], v60 offset:1024
    ds_read_b64_tr_b16 v[166:167], v60 offset:1536
    v_mfma_f32_16x16x32_bf16 v[36:39], v[156:159], v[136:139], v[36:39]
    v_mfma_f32_16x16x32_bf16 v[44:47], v[156:159], v[140:143], v[44:47]
    v_mfma_f32_16x16x32_bf16 v[40:43], v[152:155], v[140:143], v[40:43]
    v_mfma_f32_16x16x32_bf16 v[48:51], v[152:155], v[144:147], v[48:51]
    v_mfma_f32_16x16x32_bf16 v[52:55], v[156:159], v[144:147], v[52:55]
    v_mfma_f32_16x16x32_bf16 v[124:127], v[156:159], v[148:151], v[124:127]
    v_mfma_f32_16x16x32_bf16 v[120:123], v[152:155], v[148:151], v[120:123]
    s_barrier
    ds_read_b64_tr_b16 v[168:169], v61 offset:0
    ds_read_b64_tr_b16 v[170:171], v61 offset:512
    s_waitcnt lgkmcnt(2)
    v_mfma_f32_16x16x32_bf16 v[32:35], v[160:163], v[132:135], v[32:35]
    ds_read_b64_tr_b16 v[172:173], v61 offset:1024
    ds_read_b64_tr_b16 v[174:175], v61 offset:1536
    v_mfma_f32_16x16x32_bf16 v[36:39], v[164:167], v[132:135], v[36:39]
    v_mfma_f32_16x16x32_bf16 v[44:47], v[164:167], v[136:139], v[44:47]
    v_mfma_f32_16x16x32_bf16 v[40:43], v[160:163], v[136:139], v[40:43]
    v_mfma_f32_16x16x32_bf16 v[48:51], v[160:163], v[140:143], v[48:51]
    v_mfma_f32_16x16x32_bf16 v[52:55], v[164:167], v[140:143], v[52:55]
    v_mfma_f32_16x16x32_bf16 v[124:127], v[164:167], v[144:147], v[124:127]
    v_mfma_f32_16x16x32_bf16 v[120:123], v[160:163], v[144:147], v[120:123]
    s_waitcnt lgkmcnt(0)
    v_mfma_f32_16x16x32_bf16 v[32:35], v[168:171], v[128:131], v[32:35]
    v_mfma_f32_16x16x32_bf16 v[36:39], v[172:175], v[128:131], v[36:39]
    v_mfma_f32_16x16x32_bf16 v[44:47], v[172:175], v[132:135], v[44:47]
    v_mfma_f32_16x16x32_bf16 v[40:43], v[168:171], v[132:135], v[40:43]
    v_mfma_f32_16x16x32_bf16 v[48:51], v[168:171], v[136:139], v[48:51]
    v_mfma_f32_16x16x32_bf16 v[52:55], v[172:175], v[136:139], v[52:55]
    v_mfma_f32_16x16x32_bf16 v[124:127], v[172:175], v[140:143], v[124:127]
    v_mfma_f32_16x16x32_bf16 v[120:123], v[168:171], v[140:143], v[120:123]
    s_nop 1
L_epi:
    v_pk_mul_f32 v[64:65], v[32:33], s[42:43]
    v_pk_mul_f32 v[66:67], v[34:35], s[42:43]
    v_pk_mul_f32 v[68:69], v[40:41], s[42:43]
    v_pk_mul_f32 v[70:71], v[42:43], s[42:43]
    v_pk_mul_f32 v[72:73], v[36:37], s[30:31]
    v_pk_mul_f32 v[74:75], v[38:39], s[30:31]
    v_pk_mul_f32 v[76:77], v[44:45], s[30:31]
    v_pk_mul_f32 v[78:79], v[46:47], s[30:31]
    v_exp_f32 v64, -|v64|
    v_exp_f32 v65, -|v65|
    v_exp_f32 v66, -|v66|
    v_exp_f32 v67, -|v67|
    v_exp_f32 v68, -|v68|
    v_exp_f32 v69, -|v69|
    v_exp_f32 v70, -|v70|
    v_exp_f32 v71, -|v71|
    v_exp_f32 v72, v72
    v_exp_f32 v73, v73
    v_exp_f32 v74, v74
    v_exp_f32 v75, v75
    v_exp_f32 v76, v76
    v_exp_f32 v77, v77
    v_exp_f32 v78, v78
    v_exp_f32 v79, v79
    v_pk_add_f32 v[80:81], v[64:65], 1.0 op_sel_hi:[1,0]
    v_pk_add_f32 v[82:83], v[66:67], 1.0 op_sel_hi:[1,0]
    v_pk_add_f32 v[84:85], v[68:69], 1.0 op_sel_hi:[1,0]
    v_pk_add_f32 v[86:87], v[70:71], 1.0 op_sel_hi:[1,0]
    v_pk_fma_f32 v[72:73], v[80:81], v[72:73], v[80:81]
    v_pk_fma_f32 v[74:75], v[82:83], v[74:75], v[82:83]
    v_pk_fma_f32 v[76:77], v[84:85], v[76:77], v[84:85]
    v_pk_fma_f32 v[78:79], v[86:87], v[78:79], v[86:87]
    v_rcp_f32 v72, v72
    v_rcp_f32 v73, v73
    v_rcp_f32 v74, v74
    v_rcp_f32 v75, v75
    v_rcp_f32 v76, v76
    v_rcp_f32 v77, v77
    v_rcp_f32 v78, v78
    v_rcp_f32 v79, v79
    s_barrier
    s_mov_b64 exec, s[94:95]
    s_cbranch_execz L_hb24
    global_atomic_add v114, v115, s[54:55] sc1
L_hb24:
    s_mov_b64 exec, -1
    v_pk_add_f32 v[64:65], v[64:65], s[28:29] neg_lo:[1,0] neg_hi:[1,0]
    v_pk_add_f32 v[66:67], v[66:67], s[28:29] neg_lo:[1,0] neg_hi:[1,0]
    v_pk_add_f32 v[68:69], v[68:69], s[28:29] neg_lo:[1,0] neg_hi:[1,0]
    v_pk_add_f32 v[70:71], v[70:71], s[28:29] neg_lo:[1,0] neg_hi:[1,0]
    v_pk_mul_f32 v[80:81], v[80:81], v[32:33]
    v_pk_mul_f32 v[82:83], v[82:83], v[34:35]
    v_pk_mul_f32 v[84:85], v[84:85], v[40:41]
    v_pk_mul_f32 v[86:87], v[86:87], v[42:43]
    v_med3_f32 v80, v80, -v64, v64
    v_med3_f32 v81, v81, -v65, v65
    v_med3_f32 v82, v82, -v66, v66
    v_med3_f32 v83, v83, -v67, v67
    v_med3_f32 v84, v84, -v68, v68
    v_med3_f32 v85, v85, -v69, v69
    v_med3_f32 v86, v86, -v70, v70
    v_med3_f32 v87, v87, -v71, v71
    v_pk_mul_f32 v[80:81], v[80:81], v[72:73]
    v_pk_mul_f32 v[82:83], v[82:83], v[74:75]
    v_pk_mul_f32 v[84:85], v[84:85], v[76:77]
    v_pk_mul_f32 v[86:87], v[86:87], v[78:79]
    v_cvt_pk_bf16_f32 v96, v80, v81
    v_cvt_pk_bf16_f32 v98, v84, v85
    v_cvt_pk_bf16_f32 v97, v82, v83
    v_cvt_pk_bf16_f32 v99, v86, v87
    v_permlane32_swap_b32 v96, v98
    v_pk_mul_f32 v[64:65], v[48:49], s[42:43]
    v_permlane32_swap_b32 v97, v99
    global_store_dwordx4 v10, v[96:99], s[54:55] sc1
    v_pk_mul_f32 v[66:67], v[50:51], s[42:43]
    v_pk_mul_f32 v[68:69], v[120:121], s[42:43]
    v_pk_mul_f32 v[70:71], v[122:123], s[42:43]
    v_pk_mul_f32 v[72:73], v[52:53], s[30:31]
    v_pk_mul_f32 v[74:75], v[54:55], s[30:31]
    v_pk_mul_f32 v[76:77], v[124:125], s[30:31]
    v_pk_mul_f32 v[78:79], v[126:127], s[30:31]
    v_exp_f32 v64, -|v64|
    v_exp_f32 v65, -|v65|
    v_exp_f32 v66, -|v66|
    v_exp_f32 v67, -|v67|
    v_exp_f32 v68, -|v68|
    v_exp_f32 v69, -|v69|
    v_exp_f32 v70, -|v70|
    v_exp_f32 v71, -|v71|
    v_exp_f32 v72, v72
    v_exp_f32 v73, v73
    v_exp_f32 v74, v74
    v_exp_f32 v75, v75
    v_exp_f32 v76, v76
    v_exp_f32 v77, v77
    v_exp_f32 v78, v78
    v_exp_f32 v79, v79
    v_pk_add_f32 v[80:81], v[64:65], 1.0 op_sel_hi:[1,0]
    v_pk_add_f32 v[82:83], v[66:67], 1.0 op_sel_hi:[1,0]
    v_pk_add_f32 v[84:85], v[68:69], 1.0 op_sel_hi:[1,0]
    v_pk_add_f32 v[86:87], v[70:71], 1.0 op_sel_hi:[1,0]
    v_pk_fma_f32 v[72:73], v[80:81], v[72:73], v[80:81]
    v_pk_fma_f32 v[74:75], v[82:83], v[74:75], v[82:83]
    v_pk_fma_f32 v[76:77], v[84:85], v[76:77], v[84:85]
    v_pk_fma_f32 v[78:79], v[86:87], v[78:79], v[86:87]
    v_rcp_f32 v72, v72
    v_rcp_f32 v73, v73
    v_rcp_f32 v74, v74
    v_rcp_f32 v75, v75
    v_rcp_f32 v76, v76
    v_rcp_f32 v77, v77
    v_rcp_f32 v78, v78
    v_rcp_f32 v79, v79
    v_pk_add_f32 v[64:65], v[64:65], s[28:29] neg_lo:[1,0] neg_hi:[1,0]
    v_pk_add_f32 v[66:67], v[66:67], s[28:29] neg_lo:[1,0] neg_hi:[1,0]
    v_pk_add_f32 v[68:69], v[68:69], s[28:29] neg_lo:[1,0] neg_hi:[1,0]
    v_pk_add_f32 v[70:71], v[70:71], s[28:29] neg_lo:[1,0] neg_hi:[1,0]
    v_pk_mul_f32 v[80:81], v[80:81], v[48:49]
    v_pk_mul_f32 v[82:83], v[82:83], v[50:51]
    v_pk_mul_f32 v[84:85], v[84:85], v[120:121]
    v_pk_mul_f32 v[86:87], v[86:87], v[122:123]
    v_med3_f32 v80, v80, -v64, v64
    v_med3_f32 v81, v81, -v65, v65
    v_med3_f32 v82, v82, -v66, v66
    v_med3_f32 v83, v83, -v67, v67
    v_med3_f32 v84, v84, -v68, v68
    v_med3_f32 v85, v85, -v69, v69
    v_med3_f32 v86, v86, -v70, v70
    v_med3_f32 v87, v87, -v71, v71
    v_pk_mul_f32 v[80:81], v[80:81], v[72:73]
    v_pk_mul_f32 v[82:83], v[82:83], v[74:75]
    v_pk_mul_f32 v[84:85], v[84:85], v[76:77]
    v_pk_mul_f32 v[86:87], v[86:87], v[78:79]
    v_cvt_pk_bf16_f32 v100, v80, v81
    v_cvt_pk_bf16_f32 v102, v84, v85
    v_cvt_pk_bf16_f32 v101, v82, v83
    v_cvt_pk_bf16_f32 v103, v86, v87
    v_permlane32_swap_b32 v100, v102
    s_nop 0
    v_permlane32_swap_b32 v101, v103
    global_store_dwordx4 v11, v[100:103], s[54:55] sc1
L_epe:
    s_barrier
    ds_read_b64_tr_b16 v[128:129], v116 offset:28672
    ds_read_b64_tr_b16 v[130:131], v116 offset:29184
    ds_read_b64_tr_b16 v[132:133], v117 offset:28672
    ds_read_b64_tr_b16 v[134:135], v117 offset:29184
    ds_read_b64_tr_b16 v[136:137], v14 offset:0
    ds_read_b64_tr_b16 v[138:139], v14 offset:512
    ds_read_b64_tr_b16 v[140:141], v15 offset:0
    ds_read_b64_tr_b16 v[142:143], v15 offset:512
    ds_read_b64_tr_b16 v[144:145], v14 offset:4096
    ds_read_b64_tr_b16 v[146:147], v14 offset:4608
    ds_read_b64_tr_b16 v[148:149], v15 offset:4096
    ds_read_b64_tr_b16 v[150:151], v15 offset:4608
    ds_read_b64_tr_b16 v[152:153], v14 offset:8192
    ds_read_b64_tr_b16 v[154:155], v14 offset:8704
    ds_read_b64_tr_b16 v[156:157], v15 offset:8192
    ds_read_b64_tr_b16 v[158:159], v15 offset:8704
    ds_read_b64_tr_b16 v[160:161], v14 offset:12288
    ds_read_b64_tr_b16 v[162:163], v14 offset:12800
    ds_read_b64_tr_b16 v[164:165], v15 offset:12288
    ds_read_b64_tr_b16 v[166:167], v15 offset:12800
    ds_read_b64_tr_b16 v[168:169], v14 offset:16384
    ds_read_b64_tr_b16 v[170:171], v14 offset:16896
    ds_read_b64_tr_b16 v[172:173], v15 offset:16384
    ds_read_b64_tr_b16 v[174:175], v15 offset:16896
    ds_read_b64_tr_b16 v[176:177], v14 offset:20480
    ds_read_b64_tr_b16 v[178:179], v14 offset:20992
    ds_read_b64_tr_b16 v[180:181], v15 offset:20480
    ds_read_b64_tr_b16 v[182:183], v15 offset:20992
    ds_read_b64_tr_b16 v[184:185], v14 offset:24576
    ds_read_b64_tr_b16 v[186:187], v14 offset:25088
    ds_read_b64_tr_b16 v[188:189], v15 offset:24576
    ds_read_b64_tr_b16 v[190:191], v15 offset:25088
    ds_read_b64_tr_b16 v[192:193], v14 offset:28672
    ds_read_b64_tr_b16 v[194:195], v14 offset:29184
    ds_read_b64_tr_b16 v[196:197], v15 offset:28672
    ds_read_b64_tr_b16 v[198:199], v15 offset:29184
    ds_read_b64_tr_b16 v[200:201], v116 offset:0
    ds_read_b64_tr_b16 v[202:203], v116 offset:512
    ds_read_b64_tr_b16 v[204:205], v117 offset:0
    ds_read_b64_tr_b16 v[206:207], v117 offset:512
    ds_read_b64_tr_b16 v[208:209], v116 offset:4096
    ds_read_b64_tr_b16 v[210:211], v116 offset:4608
    ds_read_b64_tr_b16 v[212:213], v117 offset:4096
    ds_read_b64_tr_b16 v[214:215], v117 offset:4608
    ds_read_b64_tr_b16 v[216:217], v14 offset:32768
    ds_read_b64_tr_b16 v[218:219], v14 offset:33280
    ds_read_b64_tr_b16 v[220:221], v15 offset:32768
    ds_read_b64_tr_b16 v[222:223], v15 offset:33280
    ds_read_b64_tr_b16 v[224:225], v14 offset:36864
    ds_read_b64_tr_b16 v[226:227], v14 offset:37376
    ds_read_b64_tr_b16 v[228:229], v15 offset:36864
    ds_read_b64_tr_b16 v[230:231], v15 offset:37376
    ds_read_b64_tr_b16 v[232:233], v14 offset:40960
    ds_read_b64_tr_b16 v[234:235], v14 offset:41472
    ds_read_b64_tr_b16 v[236:237], v15 offset:40960
    ds_read_b64_tr_b16 v[238:239], v15 offset:41472
    ds_read_b64_tr_b16 v[240:241], v14 offset:45056
    ds_read_b64_tr_b16 v[242:243], v14 offset:45568
    ds_read_b64_tr_b16 v[244:245], v15 offset:45056
    ds_read_b64_tr_b16 v[246:247], v15 offset:45568
    ds_read_b64_tr_b16 v[248:249], v14 offset:49152
    ds_read_b64_tr_b16 v[250:251], v14 offset:49664
    ds_read_b64_tr_b16 v[252:253], v15 offset:49152
    ds_read_b64_tr_b16 v[254:255], v15 offset:49664
    s_mov_b32 s39, 0
    s_barrier
    ds_read_b128 v[64:67], v23 offset:0
    ds_read_b128 v[68:71], v23 offset:1024
    ds_read_b128 v[72:75], v23 offset:4096
    s_waitcnt lgkmcnt(2)
    v_mfma_f32_16x16x32_bf16 v[32:35], v[128:131], v[64:67], 0
    ds_read_b128 v[76:79], v23 offset:5120
    v_mfma_f32_16x16x32_bf16 v[36:39], v[132:135], v[64:67], 0
    s_waitcnt lgkmcnt(2)
    v_mfma_f32_16x16x32_bf16 v[32:35], v[136:139], v[68:71], v[32:35]
    s_barrier
    ds_read_b128 v[64:67], v23 offset:8192
    v_mfma_f32_16x16x32_bf16 v[36:39], v[140:143], v[68:71], v[36:39]
    s_waitcnt lgkmcnt(2)
    v_mfma_f32_16x16x32_bf16 v[32:35], v[144:147], v[72:75], v[32:35]
    ds_read_b128 v[68:71], v23 offset:9216
    v_mfma_f32_16x16x32_bf16 v[36:39], v[148:151], v[72:75], v[36:39]
    s_waitcnt lgkmcnt(2)
    v_mfma_f32_16x16x32_bf16 v[32:35], v[152:155], v[76:79], v[32:35]
    ds_read_b128 v[72:75], v23 offset:12288
    v_mfma_f32_16x16x32_bf16 v[36:39], v[156:159], v[76:79], v[36:39]
    s_waitcnt lgkmcnt(2)
    v_mfma_f32_16x16x32_bf16 v[32:35], v[160:163], v[64:67], v[32:35]
    ds_read_b128 v[76:79], v23 offset:13312
    v_mfma_f32_16x16x32_bf16 v[36:39], v[164:167], v[64:67], v[36:39]
    s_waitcnt lgkmcnt(2)
    v_mfma_f32_16x16x32_bf16 v[32:35], v[168:171], v[68:71], v[32:35]
    s_barrier
    ds_read_b128 v[64:67], v23 offset:16384
    v_mfma_f32_16x16x32_bf16 v[36:39], v[172:175], v[68:71], v[36:39]
    s_waitcnt lgkmcnt(2)
    v_mfma_f32_16x16x32_bf16 v[32:35], v[176:179], v[72:75], v[32:35]
    ds_read_b128 v[68:71], v23 offset:17408
    v_mfma_f32_16x16x32_bf16 v[36:39], v[180:183], v[72:75], v[36:39]
    s_waitcnt lgkmcnt(2)
    v_mfma_f32_16x16x32_bf16 v[32:35], v[184:187], v[76:79], v[32:35]
    ds_read_b128 v[72:75], v23 offset:20480
    v_mfma_f32_16x16x32_bf16 v[36:39], v[188:191], v[76:79], v[36:39]
    s_waitcnt lgkmcnt(2)
    v_mfma_f32_16x16x32_bf16 v[32:35], v[192:195], v[64:67], v[32:35]
    ds_read_b128 v[76:79], v23 offset:21504
    v_mfma_f32_16x16x32_bf16 v[36:39], v[196:199], v[64:67], v[36:39]
    s_waitcnt lgkmcnt(2)
    v_mfma_f32_16x16x32_bf16 v[32:35], v[200:203], v[68:71], v[32:35]
    s_barrier
    ds_read_b128 v[64:67], v23 offset:24576
    v_mfma_f32_16x16x32_bf16 v[36:39], v[204:207], v[68:71], v[36:39]
    s_waitcnt lgkmcnt(2)
    v_mfma_f32_16x16x32_bf16 v[32:35], v[208:211], v[72:75], v[32:35]
    ds_read_b128 v[68:71], v23 offset:25600
    v_mfma_f32_16x16x32_bf16 v[36:39], v[212:215], v[72:75], v[36:39]
    s_waitcnt lgkmcnt(2)
    v_mfma_f32_16x16x32_bf16 v[32:35], v[216:219], v[76:79], v[32:35]
    ds_read_b128 v[72:75], v23 offset:28672
    v_mfma_f32_16x16x32_bf16 v[36:39], v[220:223], v[76:79], v[36:39]
    s_waitcnt lgkmcnt(2)
    v_mfma_f32_16x16x32_bf16 v[32:35], v[224:227], v[64:67], v[32:35]
    ds_read_b128 v[76:79], v23 offset:29696
    v_mfma_f32_16x16x32_bf16 v[36:39], v[228:231], v[64:67], v[36:39]
    s_waitcnt lgkmcnt(2)
    v_mfma_f32_16x16x32_bf16 v[32:35], v[232:235], v[68:71], v[32:35]
    s_barrier
    ds_read_b128 v[64:67], v23 offset:32768
    v_mfma_f32_16x16x32_bf16 v[36:39], v[236:239], v[68:71], v[36:39]
    s_waitcnt lgkmcnt(2)
    v_mfma_f32_16x16x32_bf16 v[32:35], v[240:243], v[72:75], v[32:35]
    ds_read_b128 v[68:71], v23 offset:33792
    v_mfma_f32_16x16x32_bf16 v[36:39], v[244:247], v[72:75], v[36:39]
    s_waitcnt lgkmcnt(2)
    v_mfma_f32_16x16x32_bf16 v[32:35], v[248:251], v[76:79], v[32:35]
    ds_read_b128 v[72:75], v23 offset:36864
    v_mfma_f32_16x16x32_bf16 v[36:39], v[252:255], v[76:79], v[36:39]
    s_waitcnt lgkmcnt(2)
    v_mfma_f32_16x16x32_bf16 v[40:43], v[128:131], v[64:67], 0
    ds_read_b128 v[76:79], v23 offset:37888
    v_mfma_f32_16x16x32_bf16 v[44:47], v[132:135], v[64:67], 0
    s_waitcnt lgkmcnt(2)
    v_mfma_f32_16x16x32_bf16 v[40:43], v[136:139], v[68:71], v[40:43]
    s_barrier
    ds_read_b128 v[64:67], v23 offset:40960
    v_mfma_f32_16x16x32_bf16 v[44:47], v[140:143], v[68:71], v[44:47]
    s_waitcnt lgkmcnt(2)
    v_mfma_f32_16x16x32_bf16 v[40:43], v[144:147], v[72:75], v[40:43]
    ds_read_b128 v[68:71], v23 offset:41984
    v_mfma_f32_16x16x32_bf16 v[44:47], v[148:151], v[72:75], v[44:47]
    v_cvt_pk_bf16_f32 v48, v32, v33
    v_cvt_pk_bf16_f32 v50, v36, v37
    s_waitcnt lgkmcnt(2)
    v_mfma_f32_16x16x32_bf16 v[40:43], v[152:155], v[76:79], v[40:43]
    ds_read_b128 v[72:75], v23 offset:45056
    v_mfma_f32_16x16x32_bf16 v[44:47], v[156:159], v[76:79], v[44:47]
    v_cvt_pk_bf16_f32 v49, v34, v35
    v_cvt_pk_bf16_f32 v51, v38, v39
    s_waitcnt lgkmcnt(2)
    v_mfma_f32_16x16x32_bf16 v[40:43], v[160:163], v[64:67], v[40:43]
    ds_read_b128 v[76:79], v23 offset:46080
    v_mfma_f32_16x16x32_bf16 v[44:47], v[164:167], v[64:67], v[44:47]
    v_permlane16_swap_b32 v48, v50
    v_permlane16_swap_b32 v49, v51
    s_waitcnt lgkmcnt(2)
    v_mfma_f32_16x16x32_bf16 v[40:43], v[168:171], v[68:71], v[40:43]
    s_barrier
    ds_read_b128 v[64:67], v23 offset:49152
    v_mfma_f32_16x16x32_bf16 v[44:47], v[172:175], v[68:71], v[44:47]
    buffer_store_dwordx4 v[48:51], v24, s[4:7], 0 offen sc1
    s_waitcnt lgkmcnt(2)
    v_mfma_f32_16x16x32_bf16 v[40:43], v[176:179], v[72:75], v[40:43]
    ds_read_b128 v[68:71], v23 offset:50176
    v_mfma_f32_16x16x32_bf16 v[44:47], v[180:183], v[72:75], v[44:47]
    v_cmp_u_f32 s[22:23], v32, v32
    s_waitcnt lgkmcnt(2)
    v_mfma_f32_16x16x32_bf16 v[40:43], v[184:187], v[76:79], v[40:43]
    ds_read_b128 v[72:75], v23 offset:53248
    v_mfma_f32_16x16x32_bf16 v[44:47], v[188:191], v[76:79], v[44:47]
    s_waitcnt lgkmcnt(2)
    v_mfma_f32_16x16x32_bf16 v[40:43], v[192:195], v[64:67], v[40:43]
    ds_read_b128 v[76:79], v23 offset:54272
    v_mfma_f32_16x16x32_bf16 v[44:47], v[196:199], v[64:67], v[44:47]
    s_waitcnt lgkmcnt(2)
    v_mfma_f32_16x16x32_bf16 v[40:43], v[200:203], v[68:71], v[40:43]
    s_barrier
    ds_read_b128 v[64:67], v23 offset:57344
    v_mfma_f32_16x16x32_bf16 v[44:47], v[204:207], v[68:71], v[44:47]
    s_waitcnt lgkmcnt(2)
    v_mfma_f32_16x16x32_bf16 v[40:43], v[208:211], v[72:75], v[40:43]
    ds_read_b128 v[68:71], v23 offset:58368
    v_mfma_f32_16x16x32_bf16 v[44:47], v[212:215], v[72:75], v[44:47]
    s_waitcnt lgkmcnt(2)
    v_mfma_f32_16x16x32_bf16 v[40:43], v[216:219], v[76:79], v[40:43]
    ds_read_b128 v[72:75], v23 offset:61440
    v_mfma_f32_16x16x32_bf16 v[44:47], v[220:223], v[76:79], v[44:47]
    s_waitcnt lgkmcnt(2)
    v_mfma_f32_16x16x32_bf16 v[40:43], v[224:227], v[64:67], v[40:43]
    ds_read_b128 v[76:79], v23 offset:62464
    v_mfma_f32_16x16x32_bf16 v[44:47], v[228:231], v[64:67], v[44:47]
    s_waitcnt lgkmcnt(2)
    v_mfma_f32_16x16x32_bf16 v[40:43], v[232:235], v[68:71], v[40:43]
    v_mfma_f32_16x16x32_bf16 v[44:47], v[236:239], v[68:71], v[44:47]
    s_waitcnt lgkmcnt(1)
    v_mfma_f32_16x16x32_bf16 v[40:43], v[240:243], v[72:75], v[40:43]
    v_mfma_f32_16x16x32_bf16 v[44:47], v[244:247], v[72:75], v[44:47]
    s_waitcnt lgkmcnt(0)
    v_mfma_f32_16x16x32_bf16 v[40:43], v[248:251], v[76:79], v[40:43]
    v_mfma_f32_16x16x32_bf16 v[44:47], v[252:255], v[76:79], v[44:47]
    s_nop 6
    v_cvt_pk_bf16_f32 v52, v40, v41
    v_cvt_pk_bf16_f32 v53, v42, v43
    v_cvt_pk_bf16_f32 v54, v44, v45
    v_cvt_pk_bf16_f32 v55, v46, v47
    v_cmp_u_f32 vcc, v40, v40
    v_permlane16_swap_b32 v52, v54
    v_permlane16_swap_b32 v53, v55
    buffer_store_dwordx4 v[52:55], v25, s[4:7], 0 offen sc1
    s_cmp_lg_u64 s[22:23], 0
    s_cbranch_scc1 L_slow0
L_cont0:
    s_cbranch_vccnz L_slow1
L_cont1:
L_end:
    s_endpgm
L_slow0:
    s_lshl_b32 s17, s56, 16
    s_mul_i32 s18, s58, 40960
    s_or_b32 s17, s17, s18
    s_or_b32 s17, s17, 2097152
    s_lshl_b32 s18, s59, 11
    s_and_b32 s20, s18, 0x3800
    s_xor_b32 s20, s20, s17
    s_add_u32 s18, s18, 2048
    buffer_load_dwordx4 v[64:67], v9, s[60:63], s20 offen offset:0 sc1
    buffer_load_dwordx4 v[68:71], v9, s[60:63], s20 offen offset:1024 sc1
    s_and_b32 s20, s18, 0x3800
    s_xor_b32 s20, s20, s17
    s_add_u32 s18, s18, 2048
    buffer_load_dwordx4 v[72:75], v9, s[60:63], s20 offen offset:0 sc1
    buffer_load_dwordx4 v[76:79], v9, s[60:63], s20 offen offset:1024 sc1
    s_and_b32 s20, s18, 0x3800
    s_xor_b32 s20, s20, s17
    s_add_u32 s18, s18, 2048
    buffer_load_dwordx4 v[80:83], v9, s[60:63], s20 offen offset:0 sc1
    buffer_load_dwordx4 v[84:87], v9, s[60:63], s20 offen offset:1024 sc1
    s_and_b32 s20, s18, 0x3800
    s_xor_b32 s20, s20, s17
    s_add_u32 s18, s18, 2048
    buffer_load_dwordx4 v[88:91], v9, s[60:63], s20 offen offset:0 sc1
    buffer_load_dwordx4 v[92:95], v9, s[60:63], s20 offen offset:1024 sc1
    s_and_b32 s20, s18, 0x3800
    s_xor_b32 s20, s20, s17
    s_add_u32 s18, s18, 2048
    buffer_load_dwordx4 v[96:99], v9, s[60:63], s20 offen offset:0 sc1
    buffer_load_dwordx4 v[100:103], v9, s[60:63], s20 offen offset:1024 sc1
    s_and_b32 s20, s18, 0x3800
    s_xor_b32 s20, s20, s17
    s_add_u32 s18, s18, 2048
    buffer_load_dwordx4 v[104:107], v9, s[60:63], s20 offen offset:0 sc1
    buffer_load_dwordx4 v[108:111], v9, s[60:63], s20 offen offset:1024 sc1
    s_and_b32 s20, s18, 0x3800
    s_xor_b32 s20, s20, s17
    s_add_u32 s18, s18, 2048
    buffer_load_dwordx4 v[112:115], v9, s[60:63], s20 offen offset:0 sc1
    buffer_load_dwordx4 v[116:119], v9, s[60:63], s20 offen offset:1024 sc1
    s_and_b32 s20, s18, 0x3800
    s_xor_b32 s20, s20, s17
    s_add_u32 s18, s18, 2048
    buffer_load_dwordx4 v[120:123], v9, s[60:63], s20 offen offset:0 sc1
    buffer_load_dwordx4 v[124:127], v9, s[60:63], s20 offen offset:1024 sc1
    s_add_u32 s39, s39, 1
    s_mov_b64 s[20:21], 0
    s_waitcnt vmcnt(0)
    v_cmp_eq_u32 vcc, s67, v64
    s_or_b64 s[20:21], s[20:21], vcc
    v_cmp_eq_u32 vcc, s67, v65
    s_or_b64 s[20:21], s[20:21], vcc
    v_cmp_eq_u32 vcc, s67, v66
    s_or_b64 s[20:21], s[20:21], vcc
    v_cmp_eq_u32 vcc, s67, v67
    s_or_b64 s[20:21], s[20:21], vcc
    v_cmp_eq_u32 vcc, s67, v68
    s_or_b64 s[20:21], s[20:21], vcc
    v_cmp_eq_u32 vcc, s67, v69
    s_or_b64 s[20:21], s[20:21], vcc
    v_cmp_eq_u32 vcc, s67, v70
    s_or_b64 s[20:21], s[20:21], vcc
    v_cmp_eq_u32 vcc, s67, v71
    s_or_b64 s[20:21], s[20:21], vcc
    v_cmp_eq_u32 vcc, s67, v72
    s_or_b64 s[20:21], s[20:21], vcc
    v_cmp_eq_u32 vcc, s67, v73
    s_or_b64 s[20:21], s[20:21], vcc
    v_cmp_eq_u32 vcc, s67, v74
    s_or_b64 s[20:21], s[20:21], vcc
    v_cmp_eq_u32 vcc, s67, v75
    s_or_b64 s[20:21], s[20:21], vcc
    v_cmp_eq_u32 vcc, s67, v76
    s_or_b64 s[20:21], s[20:21], vcc
    v_cmp_eq_u32 vcc, s67, v77
    s_or_b64 s[20:21], s[20:21], vcc
    v_cmp_eq_u32 vcc, s67, v78
    s_or_b64 s[20:21], s[20:21], vcc
    v_cmp_eq_u32 vcc, s67, v79
    s_or_b64 s[20:21], s[20:21], vcc
    v_cmp_eq_u32 vcc, s67, v80
    s_or_b64 s[20:21], s[20:21], vcc
    v_cmp_eq_u32 vcc, s67, v81
    s_or_b64 s[20:21], s[20:21], vcc
    v_cmp_eq_u32 vcc, s67, v82
    s_or_b64 s[20:21], s[20:21], vcc
    v_cmp_eq_u32 vcc, s67, v83
    s_or_b64 s[20:21], s[20:21], vcc
    v_cmp_eq_u32 vcc, s67, v84
    s_or_b64 s[20:21], s[20:21], vcc
    v_cmp_eq_u32 vcc, s67, v85
    s_or_b64 s[20:21], s[20:21], vcc
    v_cmp_eq_u32 vcc, s67, v86
    s_or_b64 s[20:21], s[20:21], vcc
    v_cmp_eq_u32 vcc, s67, v87
    s_or_b64 s[20:21], s[20:21], vcc
    v_cmp_eq_u32 vcc, s67, v88
    s_or_b64 s[20:21], s[20:21], vcc
    v_cmp_eq_u32 vcc, s67, v89
    s_or_b64 s[20:21], s[20:21], vcc
    v_cmp_eq_u32 vcc, s67, v90
    s_or_b64 s[20:21], s[20:21], vcc
    v_cmp_eq_u32 vcc, s67, v91
    s_or_b64 s[20:21], s[20:21], vcc
    v_cmp_eq_u32 vcc, s67, v92
    s_or_b64 s[20:21], s[20:21], vcc
    v_cmp_eq_u32 vcc, s67, v93
    s_or_b64 s[20:21], s[20:21], vcc
    v_cmp_eq_u32 vcc, s67, v94
    s_or_b64 s[20:21], s[20:21], vcc
    v_cmp_eq_u32 vcc, s67, v95
    s_or_b64 s[20:21], s[20:21], vcc
    v_cmp_eq_u32 vcc, s67, v96
    s_or_b64 s[20:21], s[20:21], vcc
    v_cmp_eq_u32 vcc, s67, v97
    s_or_b64 s[20:21], s[20:21], vcc
    v_cmp_eq_u32 vcc, s67, v98
    s_or_b64 s[20:21], s[20:21], vcc
    v_cmp_eq_u32 vcc, s67, v99
    s_or_b64 s[20:21], s[20:21], vcc
    v_cmp_eq_u32 vcc, s67, v100
    s_or_b64 s[20:21], s[20:21], vcc
    v_cmp_eq_u32 vcc, s67, v101
    s_or_b64 s[20:21], s[20:21], vcc
    v_cmp_eq_u32 vcc, s67, v102
    s_or_b64 s[20:21], s[20:21], vcc
    v_cmp_eq_u32 vcc, s67, v103
    s_or_b64 s[20:21], s[20:21], vcc
    v_cmp_eq_u32 vcc, s67, v104
    s_or_b64 s[20:21], s[20:21], vcc
    v_cmp_eq_u32 vcc, s67, v105
    s_or_b64 s[20:21], s[20:21], vcc
    v_cmp_eq_u32 vcc, s67, v106
    s_or_b64 s[20:21], s[20:21], vcc
    v_cmp_eq_u32 vcc, s67, v107
    s_or_b64 s[20:21], s[20:21], vcc
    v_cmp_eq_u32 vcc, s67, v108
    s_or_b64 s[20:21], s[20:21], vcc
    v_cmp_eq_u32 vcc, s67, v109
    s_or_b64 s[20:21], s[20:21], vcc
    v_cmp_eq_u32 vcc, s67, v110
    s_or_b64 s[20:21], s[20:21], vcc
    v_cmp_eq_u32 vcc, s67, v111
    s_or_b64 s[20:21], s[20:21], vcc
    v_cmp_eq_u32 vcc, s67, v112
    s_or_b64 s[20:21], s[20:21], vcc
    v_cmp_eq_u32 vcc, s67, v113
    s_or_b64 s[20:21], s[20:21], vcc
    v_cmp_eq_u32 vcc, s67, v114
    s_or_b64 s[20:21], s[20:21], vcc
    v_cmp_eq_u32 vcc, s67, v115
    s_or_b64 s[20:21], s[20:21], vcc
    v_cmp_eq_u32 vcc, s67, v116
    s_or_b64 s[20:21], s[20:21], vcc
    v_cmp_eq_u32 vcc, s67, v117
    s_or_b64 s[20:21], s[20:21], vcc
    v_cmp_eq_u32 vcc, s67, v118
    s_or_b64 s[20:21], s[20:21], vcc
    v_cmp_eq_u32 vcc, s67, v119
    s_or_b64 s[20:21], s[20:21], vcc
    v_cmp_eq_u32 vcc, s67, v120
    s_or_b64 s[20:21], s[20:21], vcc
    v_cmp_eq_u32 vcc, s67, v121
    s_or_b64 s[20:21], s[20:21], vcc
    v_cmp_eq_u32 vcc, s67, v122
    s_or_b64 s[20:21], s[20:21], vcc
    v_cmp_eq_u32 vcc, s67, v123
    s_or_b64 s[20:21], s[20:21], vcc
    v_cmp_eq_u32 vcc, s67, v124
    s_or_b64 s[20:21], s[20:21], vcc
    v_cmp_eq_u32 vcc, s67, v125
    s_or_b64 s[20:21], s[20:21], vcc
    v_cmp_eq_u32 vcc, s67, v126
    s_or_b64 s[20:21], s[20:21], vcc
    v_cmp_eq_u32 vcc, s67, v127
    s_or_b64 s[20:21], s[20:21], vcc
    s_cmp_eq_u64 s[20:21], 0
    s_cbranch_scc1 L_redo0
    s_cmp_lt_u32 s39, 65536
    s_cbranch_scc1 L_slow0
L_redo0:
    v_mfma_f32_16x16x32_bf16 v[32:35], v[128:131], v[64:67], 0
    v_mfma_f32_16x16x32_bf16 v[36:39], v[132:135], v[64:67], 0
    v_mfma_f32_16x16x32_bf16 v[32:35], v[136:139], v[68:71], v[32:35]
    v_mfma_f32_16x16x32_bf16 v[36:39], v[140:143], v[68:71], v[36:39]
    v_mfma_f32_16x16x32_bf16 v[32:35], v[144:147], v[72:75], v[32:35]
    v_mfma_f32_16x16x32_bf16 v[36:39], v[148:151], v[72:75], v[36:39]
    v_mfma_f32_16x16x32_bf16 v[32:35], v[152:155], v[76:79], v[32:35]
    v_mfma_f32_16x16x32_bf16 v[36:39], v[156:159], v[76:79], v[36:39]
    v_mfma_f32_16x16x32_bf16 v[32:35], v[160:163], v[80:83], v[32:35]
    v_mfma_f32_16x16x32_bf16 v[36:39], v[164:167], v[80:83], v[36:39]
    v_mfma_f32_16x16x32_bf16 v[32:35], v[168:171], v[84:87], v[32:35]
    v_mfma_f32_16x16x32_bf16 v[36:39], v[172:175], v[84:87], v[36:39]
    v_mfma_f32_16x16x32_bf16 v[32:35], v[176:179], v[88:91], v[32:35]
    v_mfma_f32_16x16x32_bf16 v[36:39], v[180:183], v[88:91], v[36:39]
    v_mfma_f32_16x16x32_bf16 v[32:35], v[184:187], v[92:95], v[32:35]
    v_mfma_f32_16x16x32_bf16 v[36:39], v[188:191], v[92:95], v[36:39]
    v_mfma_f32_16x16x32_bf16 v[32:35], v[192:195], v[96:99], v[32:35]
    v_mfma_f32_16x16x32_bf16 v[36:39], v[196:199], v[96:99], v[36:39]
    v_mfma_f32_16x16x32_bf16 v[32:35], v[200:203], v[100:103], v[32:35]
    v_mfma_f32_16x16x32_bf16 v[36:39], v[204:207], v[100:103], v[36:39]
    v_mfma_f32_16x16x32_bf16 v[32:35], v[208:211], v[104:107], v[32:35]
    v_mfma_f32_16x16x32_bf16 v[36:39], v[212:215], v[104:107], v[36:39]
    v_mfma_f32_16x16x32_bf16 v[32:35], v[216:219], v[108:111], v[32:35]
    v_mfma_f32_16x16x32_bf16 v[36:39], v[220:223], v[108:111], v[36:39]
    v_mfma_f32_16x16x32_bf16 v[32:35], v[224:227], v[112:115], v[32:35]
    v_mfma_f32_16x16x32_bf16 v[36:39], v[228:231], v[112:115], v[36:39]
    v_mfma_f32_16x16x32_bf16 v[32:35], v[232:235], v[116:119], v[32:35]
    v_mfma_f32_16x16x32_bf16 v[36:39], v[236:239], v[116:119], v[36:39]
    v_mfma_f32_16x16x32_bf16 v[32:35], v[240:243], v[120:123], v[32:35]
    v_mfma_f32_16x16x32_bf16 v[36:39], v[244:247], v[120:123], v[36:39]
    v_mfma_f32_16x16x32_bf16 v[32:35], v[248:251], v[124:127], v[32:35]
    v_mfma_f32_16x16x32_bf16 v[36:39], v[252:255], v[124:127], v[36:39]
    s_nop 7
    v_cvt_pk_bf16_f32 v48, v32, v33
    v_cvt_pk_bf16_f32 v50, v36, v37
    v_cvt_pk_bf16_f32 v49, v34, v35
    v_cvt_pk_bf16_f32 v51, v38, v39
    s_nop 1
    v_permlane16_swap_b32 v48, v50
    v_permlane16_swap_b32 v49, v51
    s_nop 1
    buffer_store_dwordx4 v[48:51], v24, s[4:7], 0 offen sc1
    v_cmp_u_f32 vcc, v40, v40
    s_branch L_cont0
L_slow1:
    s_lshl_b32 s17, s56, 16
    s_mul_i32 s18, s58, 40960
    s_or_b32 s17, s17, s18
    s_or_b32 s17, s17, 2113536
    s_lshl_b32 s18, s59, 11
    s_and_b32 s20, s18, 0x3800
    s_xor_b32 s20, s20, s17
    s_add_u32 s18, s18, 2048
    buffer_load_dwordx4 v[64:67], v9, s[60:63], s20 offen offset:0 sc1
    buffer_load_dwordx4 v[68:71], v9, s[60:63], s20 offen offset:1024 sc1
    s_and_b32 s20, s18, 0x3800
    s_xor_b32 s20, s20, s17
    s_add_u32 s18, s18, 2048
    buffer_load_dwordx4 v[72:75], v9, s[60:63], s20 offen offset:0 sc1
    buffer_load_dwordx4 v[76:79], v9, s[60:63], s20 offen offset:1024 sc1
    s_and_b32 s20, s18, 0x3800
    s_xor_b32 s20, s20, s17
    s_add_u32 s18, s18, 2048
    buffer_load_dwordx4 v[80:83], v9, s[60:63], s20 offen offset:0 sc1
    buffer_load_dwordx4 v[84:87], v9, s[60:63], s20 offen offset:1024 sc1
    s_and_b32 s20, s18, 0x3800
    s_xor_b32 s20, s20, s17
    s_add_u32 s18, s18, 2048
    buffer_load_dwordx4 v[88:91], v9, s[60:63], s20 offen offset:0 sc1
    buffer_load_dwordx4 v[92:95], v9, s[60:63], s20 offen offset:1024 sc1
    s_and_b32 s20, s18, 0x3800
    s_xor_b32 s20, s20, s17
    s_add_u32 s18, s18, 2048
    buffer_load_dwordx4 v[96:99], v9, s[60:63], s20 offen offset:0 sc1
    buffer_load_dwordx4 v[100:103], v9, s[60:63], s20 offen offset:1024 sc1
    s_and_b32 s20, s18, 0x3800
    s_xor_b32 s20, s20, s17
    s_add_u32 s18, s18, 2048
    buffer_load_dwordx4 v[104:107], v9, s[60:63], s20 offen offset:0 sc1
    buffer_load_dwordx4 v[108:111], v9, s[60:63], s20 offen offset:1024 sc1
    s_and_b32 s20, s18, 0x3800
    s_xor_b32 s20, s20, s17
    s_add_u32 s18, s18, 2048
    buffer_load_dwordx4 v[112:115], v9, s[60:63], s20 offen offset:0 sc1
    buffer_load_dwordx4 v[116:119], v9, s[60:63], s20 offen offset:1024 sc1
    s_and_b32 s20, s18, 0x3800
    s_xor_b32 s20, s20, s17
    s_add_u32 s18, s18, 2048
    buffer_load_dwordx4 v[120:123], v9, s[60:63], s20 offen offset:0 sc1
    buffer_load_dwordx4 v[124:127], v9, s[60:63], s20 offen offset:1024 sc1
    s_add_u32 s39, s39, 1
    s_mov_b64 s[20:21], 0
    s_waitcnt vmcnt(0)
    v_cmp_eq_u32 vcc, s67, v64
    s_or_b64 s[20:21], s[20:21], vcc
    v_cmp_eq_u32 vcc, s67, v65
    s_or_b64 s[20:21], s[20:21], vcc
    v_cmp_eq_u32 vcc, s67, v66
    s_or_b64 s[20:21], s[20:21], vcc
    v_cmp_eq_u32 vcc, s67, v67
    s_or_b64 s[20:21], s[20:21], vcc
    v_cmp_eq_u32 vcc, s67, v68
    s_or_b64 s[20:21], s[20:21], vcc
    v_cmp_eq_u32 vcc, s67, v69
    s_or_b64 s[20:21], s[20:21], vcc
    v_cmp_eq_u32 vcc, s67, v70
    s_or_b64 s[20:21], s[20:21], vcc
    v_cmp_eq_u32 vcc, s67, v71
    s_or_b64 s[20:21], s[20:21], vcc
    v_cmp_eq_u32 vcc, s67, v72
    s_or_b64 s[20:21], s[20:21], vcc
    v_cmp_eq_u32 vcc, s67, v73
    s_or_b64 s[20:21], s[20:21], vcc
    v_cmp_eq_u32 vcc, s67, v74
    s_or_b64 s[20:21], s[20:21], vcc
    v_cmp_eq_u32 vcc, s67, v75
    s_or_b64 s[20:21], s[20:21], vcc
    v_cmp_eq_u32 vcc, s67, v76
    s_or_b64 s[20:21], s[20:21], vcc
    v_cmp_eq_u32 vcc, s67, v77
    s_or_b64 s[20:21], s[20:21], vcc
    v_cmp_eq_u32 vcc, s67, v78
    s_or_b64 s[20:21], s[20:21], vcc
    v_cmp_eq_u32 vcc, s67, v79
    s_or_b64 s[20:21], s[20:21], vcc
    v_cmp_eq_u32 vcc, s67, v80
    s_or_b64 s[20:21], s[20:21], vcc
    v_cmp_eq_u32 vcc, s67, v81
    s_or_b64 s[20:21], s[20:21], vcc
    v_cmp_eq_u32 vcc, s67, v82
    s_or_b64 s[20:21], s[20:21], vcc
    v_cmp_eq_u32 vcc, s67, v83
    s_or_b64 s[20:21], s[20:21], vcc
    v_cmp_eq_u32 vcc, s67, v84
    s_or_b64 s[20:21], s[20:21], vcc
    v_cmp_eq_u32 vcc, s67, v85
    s_or_b64 s[20:21], s[20:21], vcc
    v_cmp_eq_u32 vcc, s67, v86
    s_or_b64 s[20:21], s[20:21], vcc
    v_cmp_eq_u32 vcc, s67, v87
    s_or_b64 s[20:21], s[20:21], vcc
    v_cmp_eq_u32 vcc, s67, v88
    s_or_b64 s[20:21], s[20:21], vcc
    v_cmp_eq_u32 vcc, s67, v89
    s_or_b64 s[20:21], s[20:21], vcc
    v_cmp_eq_u32 vcc, s67, v90
    s_or_b64 s[20:21], s[20:21], vcc
    v_cmp_eq_u32 vcc, s67, v91
    s_or_b64 s[20:21], s[20:21], vcc
    v_cmp_eq_u32 vcc, s67, v92
    s_or_b64 s[20:21], s[20:21], vcc
    v_cmp_eq_u32 vcc, s67, v93
    s_or_b64 s[20:21], s[20:21], vcc
    v_cmp_eq_u32 vcc, s67, v94
    s_or_b64 s[20:21], s[20:21], vcc
    v_cmp_eq_u32 vcc, s67, v95
    s_or_b64 s[20:21], s[20:21], vcc
    v_cmp_eq_u32 vcc, s67, v96
    s_or_b64 s[20:21], s[20:21], vcc
    v_cmp_eq_u32 vcc, s67, v97
    s_or_b64 s[20:21], s[20:21], vcc
    v_cmp_eq_u32 vcc, s67, v98
    s_or_b64 s[20:21], s[20:21], vcc
    v_cmp_eq_u32 vcc, s67, v99
    s_or_b64 s[20:21], s[20:21], vcc
    v_cmp_eq_u32 vcc, s67, v100
    s_or_b64 s[20:21], s[20:21], vcc
    v_cmp_eq_u32 vcc, s67, v101
    s_or_b64 s[20:21], s[20:21], vcc
    v_cmp_eq_u32 vcc, s67, v102
    s_or_b64 s[20:21], s[20:21], vcc
    v_cmp_eq_u32 vcc, s67, v103
    s_or_b64 s[20:21], s[20:21], vcc
    v_cmp_eq_u32 vcc, s67, v104
    s_or_b64 s[20:21], s[20:21], vcc
    v_cmp_eq_u32 vcc, s67, v105
    s_or_b64 s[20:21], s[20:21], vcc
    v_cmp_eq_u32 vcc, s67, v106
    s_or_b64 s[20:21], s[20:21], vcc
    v_cmp_eq_u32 vcc, s67, v107
    s_or_b64 s[20:21], s[20:21], vcc
    v_cmp_eq_u32 vcc, s67, v108
    s_or_b64 s[20:21], s[20:21], vcc
    v_cmp_eq_u32 vcc, s67, v109
    s_or_b64 s[20:21], s[20:21], vcc
    v_cmp_eq_u32 vcc, s67, v110
    s_or_b64 s[20:21], s[20:21], vcc
    v_cmp_eq_u32 vcc, s67, v111
    s_or_b64 s[20:21], s[20:21], vcc
    v_cmp_eq_u32 vcc, s67, v112
    s_or_b64 s[20:21], s[20:21], vcc
    v_cmp_eq_u32 vcc, s67, v113
    s_or_b64 s[20:21], s[20:21], vcc
    v_cmp_eq_u32 vcc, s67, v114
    s_or_b64 s[20:21], s[20:21], vcc
    v_cmp_eq_u32 vcc, s67, v115
    s_or_b64 s[20:21], s[20:21], vcc
    v_cmp_eq_u32 vcc, s67, v116
    s_or_b64 s[20:21], s[20:21], vcc
    v_cmp_eq_u32 vcc, s67, v117
    s_or_b64 s[20:21], s[20:21], vcc
    v_cmp_eq_u32 vcc, s67, v118
    s_or_b64 s[20:21], s[20:21], vcc
    v_cmp_eq_u32 vcc, s67, v119
    s_or_b64 s[20:21], s[20:21], vcc
    v_cmp_eq_u32 vcc, s67, v120
    s_or_b64 s[20:21], s[20:21], vcc
    v_cmp_eq_u32 vcc, s67, v121
    s_or_b64 s[20:21], s[20:21], vcc
    v_cmp_eq_u32 vcc, s67, v122
    s_or_b64 s[20:21], s[20:21], vcc
    v_cmp_eq_u32 vcc, s67, v123
    s_or_b64 s[20:21], s[20:21], vcc
    v_cmp_eq_u32 vcc, s67, v124
    s_or_b64 s[20:21], s[20:21], vcc
    v_cmp_eq_u32 vcc, s67, v125
    s_or_b64 s[20:21], s[20:21], vcc
    v_cmp_eq_u32 vcc, s67, v126
    s_or_b64 s[20:21], s[20:21], vcc
    v_cmp_eq_u32 vcc, s67, v127
    s_or_b64 s[20:21], s[20:21], vcc
    s_cmp_eq_u64 s[20:21], 0
    s_cbranch_scc1 L_redo1
    s_cmp_lt_u32 s39, 65536
    s_cbranch_scc1 L_slow1
L_redo1:
    v_mfma_f32_16x16x32_bf16 v[40:43], v[128:131], v[64:67], 0
    v_mfma_f32_16x16x32_bf16 v[44:47], v[132:135], v[64:67], 0
    v_mfma_f32_16x16x32_bf16 v[40:43], v[136:139], v[68:71], v[40:43]
    v_mfma_f32_16x16x32_bf16 v[44:47], v[140:143], v[68:71], v[44:47]
    v_mfma_f32_16x16x32_bf16 v[40:43], v[144:147], v[72:75], v[40:43]
    v_mfma_f32_16x16x32_bf16 v[44:47], v[148:151], v[72:75], v[44:47]
    v_mfma_f32_16x16x32_bf16 v[40:43], v[152:155], v[76:79], v[40:43]
    v_mfma_f32_16x16x32_bf16 v[44:47], v[156:159], v[76:79], v[44:47]
    v_mfma_f32_16x16x32_bf16 v[40:43], v[160:163], v[80:83], v[40:43]
    v_mfma_f32_16x16x32_bf16 v[44:47], v[164:167], v[80:83], v[44:47]
    v_mfma_f32_16x16x32_bf16 v[40:43], v[168:171], v[84:87], v[40:43]
    v_mfma_f32_16x16x32_bf16 v[44:47], v[172:175], v[84:87], v[44:47]
    v_mfma_f32_16x16x32_bf16 v[40:43], v[176:179], v[88:91], v[40:43]
    v_mfma_f32_16x16x32_bf16 v[44:47], v[180:183], v[88:91], v[44:47]
    v_mfma_f32_16x16x32_bf16 v[40:43], v[184:187], v[92:95], v[40:43]
    v_mfma_f32_16x16x32_bf16 v[44:47], v[188:191], v[92:95], v[44:47]
    v_mfma_f32_16x16x32_bf16 v[40:43], v[192:195], v[96:99], v[40:43]
    v_mfma_f32_16x16x32_bf16 v[44:47], v[196:199], v[96:99], v[44:47]
    v_mfma_f32_16x16x32_bf16 v[40:43], v[200:203], v[100:103], v[40:43]
    v_mfma_f32_16x16x32_bf16 v[44:47], v[204:207], v[100:103], v[44:47]
    v_mfma_f32_16x16x32_bf16 v[40:43], v[208:211], v[104:107], v[40:43]
    v_mfma_f32_16x16x32_bf16 v[44:47], v[212:215], v[104:107], v[44:47]
    v_mfma_f32_16x16x32_bf16 v[40:43], v[216:219], v[108:111], v[40:43]
    v_mfma_f32_16x16x32_bf16 v[44:47], v[220:223], v[108:111], v[44:47]
    v_mfma_f32_16x16x32_bf16 v[40:43], v[224:227], v[112:115], v[40:43]
    v_mfma_f32_16x16x32_bf16 v[44:47], v[228:231], v[112:115], v[44:47]
    v_mfma_f32_16x16x32_bf16 v[40:43], v[232:235], v[116:119], v[40:43]
    v_mfma_f32_16x16x32_bf16 v[44:47], v[236:239], v[116:119], v[44:47]
    v_mfma_f32_16x16x32_bf16 v[40:43], v[240:243], v[120:123], v[40:43]
    v_mfma_f32_16x16x32_bf16 v[44:47], v[244:247], v[120:123], v[44:47]
    v_mfma_f32_16x16x32_bf16 v[40:43], v[248:251], v[124:127], v[40:43]
    v_mfma_f32_16x16x32_bf16 v[44:47], v[252:255], v[124:127], v[44:47]
    s_nop 7
    v_cvt_pk_bf16_f32 v52, v40, v41
    v_cvt_pk_bf16_f32 v54, v44, v45
    v_cvt_pk_bf16_f32 v53, v42, v43
    v_cvt_pk_bf16_f32 v55, v46, v47
    s_nop 1
    v_permlane16_swap_b32 v52, v54
    v_permlane16_swap_b32 v53, v55
    s_nop 1
    buffer_store_dwordx4 v[52:55], v25, s[4:7], 0 offen sc1
    s_branch L_cont1
L_codeend:
.section .rodata,"a"
.p2align 6
.amdhsa_kernel standalone__autoregressive_conv_wavenet__speech_kernel
  .amdhsa_next_free_vgpr 256
  .amdhsa_next_free_sgpr 102
  .amdhsa_accum_offset 256
  .amdhsa_group_segment_fixed_size 0
  .amdhsa_kernarg_size 48
  .amdhsa_user_sgpr_count 2
  .amdhsa_user_sgpr_kernarg_segment_ptr 1
  .amdhsa_system_sgpr_workgroup_id_x 1
.end_amdhsa_kernel
```
